```python
import torch

def _softmax(x, axis=-1):
    return torch.softmax(x, dim=axis)
def _gelu(x):
    return torch.nn.functional.gelu(x, approximate="tanh")
def _silu(x):
    return torch.nn.functional.silu(x)
def _sigmoid(x):
    return torch.sigmoid(x)
def _layernorm(x, axis=-1, eps=1e-5):
    m = x.mean(dim=axis, keepdim=True)
    v = x.var(dim=axis, keepdim=True, unbiased=False)
    return (x - m) / torch.sqrt(v + eps)
def _scatter_add(tgt, idx, src, axis=0):
    return tgt.clone().index_add_(axis, idx, src)
def _segment_sum(src, seg, n):
    out = torch.zeros((n,) + src.shape[1:], dtype=src.dtype)
    return out.index_add_(0, seg, src)
def _pad(x, pw):
    flat = tuple(v for pair in reversed(pw) for v in pair)
    return torch.nn.functional.pad(x, flat)

kernel_name = 'sequential_preLN__linear_kernel_hedgehog__swiglu_ffn__prompt'

def setup_inputs():

    _w = (lambda a: (lambda t: t.to(torch.bfloat16) if t.is_floating_point() else t)(torch.as_tensor(a)))
    def _A_setup():
        B, S, D, H = 1, 2048, 512, 32
        Dh = D // H
        return {
            "x": _w((lambda *s: torch.randn(*s, dtype=torch.bfloat16) * 0.05)(B, S, D)),
            "wqkv": _w((lambda *s: torch.randn(*s, dtype=torch.bfloat16) * 0.2)(D, 3 * D)),
            "w_phi": _w((lambda *s: torch.randn(*s, dtype=torch.bfloat16) * 0.2)(H, Dh, Dh) * (Dh ** -0.5)),
            "wo": _w((lambda *s: torch.randn(*s, dtype=torch.bfloat16) * 0.05)(D, D)),
        }
    _A_in = _A_setup()

    def _B_setup():
        B, S, D, F = 1, 2048, 512, 1792
        return {
            "x": _w((lambda *s: torch.randn(*s, dtype=torch.bfloat16) * 0.05)(B, S, D)),
            "w_gate": _w((lambda *s: torch.randn(*s, dtype=torch.bfloat16) * 0.05)(D, F)),
            "w_up": _w((lambda *s: torch.randn(*s, dtype=torch.bfloat16) * 0.05)(D, F)),
            "w_down": _w((lambda *s: torch.randn(*s, dtype=torch.bfloat16) * 0.05)(F, D)),
        }
    _B_in = _B_setup()

    return {
        "A_x": _A_in["x"],
        "A_wqkv": _A_in["wqkv"],
        "A_w_phi": _A_in["w_phi"],
        "A_wo": _A_in["wo"],
        "B_x": _B_in["x"],
        "B_w_gate": _B_in["w_gate"],
        "B_w_up": _B_in["w_up"],
        "B_w_down": _B_in["w_down"],
    }

def reference(A_x, A_wqkv, A_w_phi, A_wo, B_x, B_w_gate, B_w_up, B_w_down):
    def _A_ref(x, wqkv, w_phi, wo):
        B, S, D = x.shape
        H = 32; Dh = D // H
        qkv = (lambda x, *d: x.permute(*d))((x @ wqkv).reshape(B, S, 3, H, Dh), 2, 0, 3, 1, 4)
        q, k, v = qkv[0], qkv[1], qkv[2]
        pq = torch.einsum("bhsd,hdf->bhsf", q, w_phi)
        pk = torch.einsum("bhsd,hdf->bhsf", k, w_phi)
        phi_q = torch.concatenate([_softmax(pq, axis=-1), _softmax(-pq, axis=-1)], axis=-1)
        phi_k = torch.concatenate([_softmax(pk, axis=-1), _softmax(-pk, axis=-1)], axis=-1)
        kv = torch.einsum("bhsf,bhsd->bhfd", phi_k, v)
        z  = torch.einsum("bhsf->bhf", phi_k)
        num = torch.einsum("bhqf,bhfd->bhqd", phi_q, kv)
        den = torch.einsum("bhqf,bhf->bhq", phi_q, z)[..., None] + 1e-6
        o = num / den
        return (lambda x, *d: x.permute(*d))(o, 0, 2, 1, 3).reshape(B, S, D) @ wo

    def _B_ref(x, w_gate, w_up, w_down):
        g = _silu(x @ w_gate)
        u = x @ w_up
        return (g * u) @ w_down

    x = A_x
    h = x + _A_ref(_layernorm(x, axis=-1), A_wqkv, A_w_phi, A_wo)
    h2 = h + _B_ref(_layernorm(h, axis=-1), B_w_gate, B_w_up, B_w_down)
    return h2
```

```asm
; @launch kernel=k0_ln1_kernel grid=(256,1,1) block=(256,1,1) lds=0
; @launch kernel=k1_qkv_kernel grid=(256,1,1) block=(512,1,1) lds=99328
; @launch kernel=k2_attn_kernel grid=(256,1,1) block=(512,1,1) lds=131072
; @launch kernel=k3_ffn1_kernel grid=(256,1,1) block=(512,1,1) lds=144640
; @launch kernel=k4_ffn2_kernel grid=(256,1,1) block=(512,1,1) lds=131072
.amdgcn_target "amdgcn-amd-amdhsa--gfx950"
.text
.globl k0_ln1_kernel
.p2align 8
.type k0_ln1_kernel,@function
k0_ln1_kernel:
    s_cmp_ge_u32 s2, 256
    s_cbranch_scc1 k0_ln1_kernel_end
    s_load_dwordx2 s[4:5], s[0:1], 0
    s_load_dwordx2 s[6:7], s[0:1], 80
    s_load_dwordx2 s[28:29], s[0:1], 8
    s_load_dwordx2 s[30:31], s[0:1], 24
    v_and_b32 v1, 63, v0
    v_lshrrev_b32 v2, 6, v0
    s_waitcnt lgkmcnt(0)
    s_mov_b32 s8, s4
    s_mov_b32 s9, s5
    s_mov_b32 s10, 2097152
    s_mov_b32 s11, 131072
    s_mov_b32 s12, s6
    s_mov_b32 s13, s7
    s_mov_b32 s14, 2097152
    s_mov_b32 s15, 131072
    s_add_u32 s16, s6, 2097152
    s_addc_u32 s17, s7, 0
    s_mov_b32 s18, 2097152
    s_mov_b32 s19, 131072
    s_add_u32 s20, s6, 4194304
    s_addc_u32 s21, s7, 0
    s_mov_b32 s22, 131072
    s_mov_b32 s23, 131072
    v_lshlrev_b32 v3, 11, v2
    v_lshl_add_u32 v3, v1, 4, v3
    s_lshl_b32 s24, s2, 13
    buffer_load_dwordx4 v[8:11], v3, s[8:11], s24 offen
    buffer_load_dwordx4 v[12:15], v3, s[8:11], s24 offen offset:1024
    v_and_b32 v4, 127, v0
    v_lshlrev_b32 v4, 2, v4
    v_mov_b32 v5, 0
    s_lshl_b32 s25, s2, 9
    buffer_store_dword v5, v4, s[20:23], s25 offen
    v_lshrrev_b32 v6, 1, v1
    v_lshlrev_b32 v6, 10, v6
    v_and_b32 v7, 1, v1
    v_lshl_add_u32 v6, v7, 3, v6
    v_lshl_add_u32 v6, v2, 5, v6
    s_lshr_b32 s26, s2, 2
    s_lshl_b32 s26, s26, 15
    s_and_b32 s27, s2, 3
    s_lshl_b32 s27, s27, 7
    s_add_u32 s26, s26, s27
    s_waitcnt vmcnt(2)
    buffer_store_dwordx2 v[8:9], v6, s[16:19], s26 offen
    buffer_store_dwordx2 v[10:11], v6, s[16:19], s26 offen offset:512
    s_waitcnt vmcnt(3)
    buffer_store_dwordx2 v[12:13], v6, s[16:19], s26 offen offset:16
    buffer_store_dwordx2 v[14:15], v6, s[16:19], s26 offen offset:528
    s_mov_b32 s32, s28
    s_mov_b32 s33, s29
    s_mov_b32 s34, 1572864
    s_mov_b32 s35, 131072
    s_mov_b32 s36, s30
    s_mov_b32 s37, s31
    s_mov_b32 s38, 524288
    s_mov_b32 s39, 131072
    v_readfirstlane_b32 s40, v2
    s_lshr_b32 s42, s2, 3
    s_lshl_b32 s42, s42, 2
    s_add_u32 s40, s40, s42
    s_and_b32 s41, s2, 1
    s_lshl_b32 s41, s41, 9
    v_lshrrev_b32 v65, 5, v1
    v_mul_u32_u24 v64, 3072, v65
    v_and_b32 v66, 31, v1
    v_lshl_add_u32 v64, v66, 4, v64
    v_lshlrev_b32 v67, 4, v1
    s_add_u32 s42, s40, 0
    s_mul_i32 s42, s42, 6144
    s_add_u32 s42, s42, s41
    s_add_u32 s42, s42, 0
    buffer_load_dwordx4 v[68:71], v64, s[32:35], s42 offen
    s_add_u32 s42, s40, 128
    s_mul_i32 s42, s42, 6144
    s_add_u32 s42, s42, s41
    s_add_u32 s42, s42, 0
    buffer_load_dwordx4 v[72:75], v64, s[32:35], s42 offen
    s_add_u32 s42, s40, 0
    s_mul_i32 s42, s42, 6144
    s_add_u32 s42, s42, s41
    s_add_u32 s42, s42, 1024
    buffer_load_dwordx4 v[76:79], v64, s[32:35], s42 offen
    s_add_u32 s42, s40, 128
    s_mul_i32 s42, s42, 6144
    s_add_u32 s42, s42, s41
    s_add_u32 s42, s42, 1024
    buffer_load_dwordx4 v[80:83], v64, s[32:35], s42 offen
    s_add_u32 s42, s40, 0
    s_mul_i32 s42, s42, 6144
    s_add_u32 s42, s42, s41
    s_add_u32 s42, s42, 2048
    buffer_load_dwordx4 v[84:87], v64, s[32:35], s42 offen
    s_add_u32 s42, s40, 128
    s_mul_i32 s42, s42, 6144
    s_add_u32 s42, s42, s41
    s_add_u32 s42, s42, 2048
    buffer_load_dwordx4 v[88:91], v64, s[32:35], s42 offen
    s_add_u32 s42, s40, 0
    s_lshl_b32 s42, s42, 10
    buffer_load_dwordx4 v[92:95], v67, s[36:39], s42 offen
    s_add_u32 s42, s40, 128
    s_lshl_b32 s42, s42, 10
    buffer_load_dwordx4 v[96:99], v67, s[36:39], s42 offen
    s_add_u32 s42, s40, 256
    s_lshl_b32 s42, s42, 10
    buffer_load_dwordx4 v[100:103], v67, s[36:39], s42 offen
    s_add_u32 s42, s40, 384
    s_lshl_b32 s42, s42, 10
    buffer_load_dwordx4 v[104:107], v67, s[36:39], s42 offen
    v_lshlrev_b32 v16, 16, v8
    v_and_b32 v17, 4294901760, v8
    v_lshlrev_b32 v18, 16, v9
    v_and_b32 v19, 4294901760, v9
    v_lshlrev_b32 v20, 16, v10
    v_and_b32 v21, 4294901760, v10
    v_lshlrev_b32 v22, 16, v11
    v_and_b32 v23, 4294901760, v11
    v_add_f32 v32, v16, v17
    v_add_f32 v32, v32, v18
    v_add_f32 v32, v32, v19
    v_add_f32 v32, v32, v20
    v_add_f32 v32, v32, v21
    v_add_f32 v32, v32, v22
    v_add_f32 v32, v32, v23
    s_nop 1
    v_add_f32_dpp v32, v32, v32 quad_perm:[1,0,3,2] row_mask:0xf bank_mask:0xf
    s_nop 1
    v_add_f32_dpp v32, v32, v32 quad_perm:[2,3,0,1] row_mask:0xf bank_mask:0xf
    s_nop 1
    v_add_f32_dpp v32, v32, v32 row_half_mirror row_mask:0xf bank_mask:0xf
    s_nop 1
    v_add_f32_dpp v32, v32, v32 row_mirror row_mask:0xf bank_mask:0xf
    v_mov_b32 v33, v32
    s_nop 1
    v_permlane16_swap_b32 v32, v33
    v_add_f32 v32, v32, v33
    v_mov_b32 v33, v32
    s_nop 1
    v_permlane32_swap_b32 v32, v33
    v_add_f32 v32, v32, v33
    v_mul_f32 v32, 989855744, v32
    v_sub_f32 v40, v16, v32
    v_sub_f32 v41, v17, v32
    v_sub_f32 v42, v18, v32
    v_sub_f32 v43, v19, v32
    v_sub_f32 v44, v20, v32
    v_sub_f32 v45, v21, v32
    v_sub_f32 v46, v22, v32
    v_sub_f32 v47, v23, v32
    v_mul_f32 v34, v40, v40
    v_fmac_f32 v34, v41, v41
    v_fmac_f32 v34, v42, v42
    v_fmac_f32 v34, v43, v43
    v_fmac_f32 v34, v44, v44
    v_fmac_f32 v34, v45, v45
    v_fmac_f32 v34, v46, v46
    v_fmac_f32 v34, v47, v47
    s_nop 1
    v_add_f32_dpp v34, v34, v34 quad_perm:[1,0,3,2] row_mask:0xf bank_mask:0xf
    s_nop 1
    v_add_f32_dpp v34, v34, v34 quad_perm:[2,3,0,1] row_mask:0xf bank_mask:0xf
    s_nop 1
    v_add_f32_dpp v34, v34, v34 row_half_mirror row_mask:0xf bank_mask:0xf
    s_nop 1
    v_add_f32_dpp v34, v34, v34 row_mirror row_mask:0xf bank_mask:0xf
    v_mov_b32 v33, v34
    s_nop 1
    v_permlane16_swap_b32 v34, v33
    v_add_f32 v34, v34, v33
    v_mov_b32 v33, v34
    s_nop 1
    v_permlane32_swap_b32 v34, v33
    v_add_f32 v34, v34, v33
    v_mul_f32 v34, 989855744, v34
    v_cvt_pk_bf16_f32 v32, v32, v32
    v_lshlrev_b32 v32, 16, v32
    v_cvt_pk_bf16_f32 v34, v34, v34
    v_lshlrev_b32 v34, 16, v34
    v_add_f32 v34, 925353388, v34
    v_cvt_pk_bf16_f32 v34, v34, v34
    v_lshlrev_b32 v34, 16, v34
    v_sqrt_f32 v34, v34
    s_nop 0
    v_cvt_pk_bf16_f32 v34, v34, v34
    v_lshlrev_b32 v34, 16, v34
    v_rcp_f32 v34, v34
    v_sub_f32 v40, v16, v32
    v_sub_f32 v41, v17, v32
    v_sub_f32 v42, v18, v32
    v_sub_f32 v43, v19, v32
    v_sub_f32 v44, v20, v32
    v_sub_f32 v45, v21, v32
    v_sub_f32 v46, v22, v32
    v_sub_f32 v47, v23, v32
    v_cvt_pk_bf16_f32 v56, v40, v41
    v_cvt_pk_bf16_f32 v57, v42, v43
    v_cvt_pk_bf16_f32 v58, v44, v45
    v_cvt_pk_bf16_f32 v59, v46, v47
    v_lshlrev_b32 v40, 16, v56
    v_and_b32 v41, 4294901760, v56
    v_lshlrev_b32 v42, 16, v57
    v_and_b32 v43, 4294901760, v57
    v_lshlrev_b32 v44, 16, v58
    v_and_b32 v45, 4294901760, v58
    v_lshlrev_b32 v46, 16, v59
    v_and_b32 v47, 4294901760, v59
    v_mul_f32 v40, v40, v34
    v_mul_f32 v41, v41, v34
    v_mul_f32 v42, v42, v34
    v_mul_f32 v43, v43, v34
    v_mul_f32 v44, v44, v34
    v_mul_f32 v45, v45, v34
    v_mul_f32 v46, v46, v34
    v_mul_f32 v47, v47, v34
    v_cvt_pk_bf16_f32 v56, v40, v41
    v_cvt_pk_bf16_f32 v57, v42, v43
    v_cvt_pk_bf16_f32 v58, v44, v45
    v_cvt_pk_bf16_f32 v59, v46, v47
    buffer_store_dwordx2 v[56:57], v6, s[12:15], s26 offen
    buffer_store_dwordx2 v[58:59], v6, s[12:15], s26 offen offset:512
    v_lshlrev_b32 v24, 16, v12
    v_and_b32 v25, 4294901760, v12
    v_lshlrev_b32 v26, 16, v13
    v_and_b32 v27, 4294901760, v13
    v_lshlrev_b32 v28, 16, v14
    v_and_b32 v29, 4294901760, v14
    v_lshlrev_b32 v30, 16, v15
    v_and_b32 v31, 4294901760, v15
    v_add_f32 v36, v24, v25
    v_add_f32 v36, v36, v26
    v_add_f32 v36, v36, v27
    v_add_f32 v36, v36, v28
    v_add_f32 v36, v36, v29
    v_add_f32 v36, v36, v30
    v_add_f32 v36, v36, v31
    s_nop 1
    v_add_f32_dpp v36, v36, v36 quad_perm:[1,0,3,2] row_mask:0xf bank_mask:0xf
    s_nop 1
    v_add_f32_dpp v36, v36, v36 quad_perm:[2,3,0,1] row_mask:0xf bank_mask:0xf
    s_nop 1
    v_add_f32_dpp v36, v36, v36 row_half_mirror row_mask:0xf bank_mask:0xf
    s_nop 1
    v_add_f32_dpp v36, v36, v36 row_mirror row_mask:0xf bank_mask:0xf
    v_mov_b32 v37, v36
    s_nop 1
    v_permlane16_swap_b32 v36, v37
    v_add_f32 v36, v36, v37
    v_mov_b32 v37, v36
    s_nop 1
    v_permlane32_swap_b32 v36, v37
    v_add_f32 v36, v36, v37
    v_mul_f32 v36, 989855744, v36
    v_sub_f32 v48, v24, v36
    v_sub_f32 v49, v25, v36
    v_sub_f32 v50, v26, v36
    v_sub_f32 v51, v27, v36
    v_sub_f32 v52, v28, v36
    v_sub_f32 v53, v29, v36
    v_sub_f32 v54, v30, v36
    v_sub_f32 v55, v31, v36
    v_mul_f32 v38, v48, v48
    v_fmac_f32 v38, v49, v49
    v_fmac_f32 v38, v50, v50
    v_fmac_f32 v38, v51, v51
    v_fmac_f32 v38, v52, v52
    v_fmac_f32 v38, v53, v53
    v_fmac_f32 v38, v54, v54
    v_fmac_f32 v38, v55, v55
    s_nop 1
    v_add_f32_dpp v38, v38, v38 quad_perm:[1,0,3,2] row_mask:0xf bank_mask:0xf
    s_nop 1
    v_add_f32_dpp v38, v38, v38 quad_perm:[2,3,0,1] row_mask:0xf bank_mask:0xf
    s_nop 1
    v_add_f32_dpp v38, v38, v38 row_half_mirror row_mask:0xf bank_mask:0xf
    s_nop 1
    v_add_f32_dpp v38, v38, v38 row_mirror row_mask:0xf bank_mask:0xf
    v_mov_b32 v37, v38
    s_nop 1
    v_permlane16_swap_b32 v38, v37
    v_add_f32 v38, v38, v37
    v_mov_b32 v37, v38
    s_nop 1
    v_permlane32_swap_b32 v38, v37
    v_add_f32 v38, v38, v37
    v_mul_f32 v38, 989855744, v38
    v_cvt_pk_bf16_f32 v36, v36, v36
    v_lshlrev_b32 v36, 16, v36
    v_cvt_pk_bf16_f32 v38, v38, v38
    v_lshlrev_b32 v38, 16, v38
    v_add_f32 v38, 925353388, v38
    v_cvt_pk_bf16_f32 v38, v38, v38
    v_lshlrev_b32 v38, 16, v38
    v_sqrt_f32 v38, v38
    s_nop 0
    v_cvt_pk_bf16_f32 v38, v38, v38
    v_lshlrev_b32 v38, 16, v38
    v_rcp_f32 v38, v38
    v_sub_f32 v48, v24, v36
    v_sub_f32 v49, v25, v36
    v_sub_f32 v50, v26, v36
    v_sub_f32 v51, v27, v36
    v_sub_f32 v52, v28, v36
    v_sub_f32 v53, v29, v36
    v_sub_f32 v54, v30, v36
    v_sub_f32 v55, v31, v36
    v_cvt_pk_bf16_f32 v60, v48, v49
    v_cvt_pk_bf16_f32 v61, v50, v51
    v_cvt_pk_bf16_f32 v62, v52, v53
    v_cvt_pk_bf16_f32 v63, v54, v55
    v_lshlrev_b32 v48, 16, v60
    v_and_b32 v49, 4294901760, v60
    v_lshlrev_b32 v50, 16, v61
    v_and_b32 v51, 4294901760, v61
    v_lshlrev_b32 v52, 16, v62
    v_and_b32 v53, 4294901760, v62
    v_lshlrev_b32 v54, 16, v63
    v_and_b32 v55, 4294901760, v63
    v_mul_f32 v48, v48, v38
    v_mul_f32 v49, v49, v38
    v_mul_f32 v50, v50, v38
    v_mul_f32 v51, v51, v38
    v_mul_f32 v52, v52, v38
    v_mul_f32 v53, v53, v38
    v_mul_f32 v54, v54, v38
    v_mul_f32 v55, v55, v38
    v_cvt_pk_bf16_f32 v60, v48, v49
    v_cvt_pk_bf16_f32 v61, v50, v51
    v_cvt_pk_bf16_f32 v62, v52, v53
    v_cvt_pk_bf16_f32 v63, v54, v55
    buffer_store_dwordx2 v[60:61], v6, s[12:15], s26 offen offset:16
    buffer_store_dwordx2 v[62:63], v6, s[12:15], s26 offen offset:528
k0_ln1_kernel_end:
    s_endpgm
.globl k1_qkv_kernel
.p2align 8
.type k1_qkv_kernel,@function
k1_qkv_kernel:
    s_cmp_ge_u32 s2, 256
    s_cbranch_scc1 k1_qkv_kernel_end
    s_load_dwordx2 s[4:5], s[0:1], 80
    s_load_dwordx2 s[6:7], s[0:1], 8
    s_load_dwordx2 s[8:9], s[0:1], 16
    s_load_dwordx2 s[48:49], s[0:1], 40
    s_load_dwordx2 s[50:51], s[0:1], 48
    v_and_b32 v1, 63, v0
    v_lshrrev_b32 v2, 6, v0
    s_nop 0
    v_readfirstlane_b32 s32, v2
    s_and_b32 s38, s2, 7
    s_lshr_b32 s33, s38, 1
    s_and_b32 s34, s38, 1
    s_lshr_b32 s38, s2, 3
    s_lshr_b32 s39, s38, 3
    s_lshl_b32 s39, s39, 2
    s_add_u32 s33, s33, s39
    s_lshl_b32 s34, s34, 3
    s_and_b32 s39, s38, 7
    s_add_u32 s34, s34, s39
    s_and_b32 s40, s32, 3
    s_lshr_b32 s41, s32, 2
    v_lshrrev_b32 v7, 2, v1
    v_mul_u32_u24 v3, 3072, v7
    v_and_b32 v8, 3, v1
    v_lshl_add_u32 v3, v8, 4, v3
    v_lshlrev_b32 v4, 4, v1
    v_lshrrev_b32 v7, 5, v1
    v_lshlrev_b32 v7, 2, v7
    v_bfe_u32 v8, v1, 2, 2
    v_add_u32 v7, v7, v8
    v_lshlrev_b32 v5, 6, v7
    v_bfe_u32 v7, v1, 4, 1
    v_lshl_add_u32 v5, v7, 5, v5
    v_and_b32 v8, 3, v1
    v_lshl_add_u32 v5, v8, 3, v5
    v_add_u32 v6, 65536, v5
    s_waitcnt lgkmcnt(0)
    s_mov_b32 s16, s6
    s_mov_b32 s17, s7
    s_mov_b32 s18, 1572864
    s_mov_b32 s19, 131072
    s_mov_b32 s12, s4
    s_mov_b32 s13, s5
    s_mov_b32 s14, 2097152
    s_mov_b32 s15, 131072
    s_mul_i32 s35, s32, 49152
    s_lshl_b32 s38, s34, 6
    s_add_u32 s35, s35, s38
    s_lshl_b32 s36, s32, 10
    s_lshl_b32 s37, s33, 2
    s_add_u32 s37, s37, s40
    s_lshl_b32 s37, s37, 15
    s_lshl_b32 s38, s41, 10
    s_add_u32 s37, s37, s38
    s_and_b32 s44, s2, 4294967288
    s_add_u32 s44, s44, s32
    s_and_b32 s45, s2, 7
    v_lshrrev_b32 v7, 5, v1
    v_mul_u32_u24 v172, 3072, v7
    v_and_b32 v8, 31, v1
    v_lshl_add_u32 v172, v8, 4, v172
    s_add_u32 s38, s44, 0
    s_lshr_b32 s39, s38, 7
    s_lshl_b32 s39, s39, 2
    s_lshr_b32 s46, s45, 1
    s_add_u32 s39, s39, s46
    s_lshl_b32 s39, s39, 17
    s_and_b32 s38, s38, 127
    s_lshl_b32 s38, s38, 10
    s_add_u32 s38, s38, s39
    buffer_load_dwordx4 v[152:155], v4, s[12:15], s38 offen
    s_add_u32 s38, s44, 256
    s_lshr_b32 s39, s38, 7
    s_lshl_b32 s39, s39, 2
    s_lshr_b32 s46, s45, 1
    s_add_u32 s39, s39, s46
    s_lshl_b32 s39, s39, 17
    s_and_b32 s38, s38, 127
    s_lshl_b32 s38, s38, 10
    s_add_u32 s38, s38, s39
    buffer_load_dwordx4 v[156:159], v4, s[12:15], s38 offen
    s_waitcnt vmcnt(0)
    s_add_u32 s39, s36, 0
    s_mov_b32 m0, s39
    s_add_u32 s38, s35, 0
    buffer_load_dwordx4 v3, s[16:19], s38 offen lds
    s_add_u32 s39, s36, 32768
    s_mov_b32 m0, s39
    s_add_u32 s38, s35, 1024
    buffer_load_dwordx4 v3, s[16:19], s38 offen lds
    s_add_u32 s39, s36, 65536
    s_mov_b32 m0, s39
    s_add_u32 s38, s35, 2048
    buffer_load_dwordx4 v3, s[16:19], s38 offen lds
    s_mov_b32 s20, s8
    s_mov_b32 s21, s9
    s_mov_b32 s22, 16384
    s_mov_b32 s23, 131072
    s_mov_b32 m0, 98304
    s_lshl_b32 s38, s34, 10
    buffer_load_dwordx4 v4, s[20:23], s38 offen lds
    s_add_u32 s38, s37, 0
    buffer_load_dwordx4 v[16:19], v4, s[12:15], s38 offen
    s_add_u32 s38, s37, 2048
    buffer_load_dwordx4 v[20:23], v4, s[12:15], s38 offen
    s_add_u32 s38, s37, 4096
    buffer_load_dwordx4 v[24:27], v4, s[12:15], s38 offen
    s_add_u32 s38, s37, 6144
    buffer_load_dwordx4 v[28:31], v4, s[12:15], s38 offen
    s_add_u32 s39, s36, 8192
    s_mov_b32 m0, s39
    s_add_u32 s38, s35, 393216
    buffer_load_dwordx4 v3, s[16:19], s38 offen lds
    s_add_u32 s39, s36, 40960
    s_mov_b32 m0, s39
    s_add_u32 s38, s35, 394240
    buffer_load_dwordx4 v3, s[16:19], s38 offen lds
    s_add_u32 s39, s36, 73728
    s_mov_b32 m0, s39
    s_add_u32 s38, s35, 395264
    buffer_load_dwordx4 v3, s[16:19], s38 offen lds
    v_mov_b32 v104, 0
    v_mov_b32 v105, 0
    v_mov_b32 v106, 0
    v_mov_b32 v107, 0
    v_mov_b32 v108, 0
    v_mov_b32 v109, 0
    v_mov_b32 v110, 0
    v_mov_b32 v111, 0
    v_mov_b32 v112, 0
    v_mov_b32 v113, 0
    v_mov_b32 v114, 0
    v_mov_b32 v115, 0
    v_mov_b32 v116, 0
    v_mov_b32 v117, 0
    v_mov_b32 v118, 0
    v_mov_b32 v119, 0
    v_mov_b32 v120, 0
    v_mov_b32 v121, 0
    v_mov_b32 v122, 0
    v_mov_b32 v123, 0
    v_mov_b32 v124, 0
    v_mov_b32 v125, 0
    v_mov_b32 v126, 0
    v_mov_b32 v127, 0
    v_mov_b32 v128, 0
    v_mov_b32 v129, 0
    v_mov_b32 v130, 0
    v_mov_b32 v131, 0
    v_mov_b32 v132, 0
    v_mov_b32 v133, 0
    v_mov_b32 v134, 0
    v_mov_b32 v135, 0
    v_mov_b32 v136, 0
    v_mov_b32 v137, 0
    v_mov_b32 v138, 0
    v_mov_b32 v139, 0
    v_mov_b32 v140, 0
    v_mov_b32 v141, 0
    v_mov_b32 v142, 0
    v_mov_b32 v143, 0
    v_mov_b32 v144, 0
    v_mov_b32 v145, 0
    v_mov_b32 v146, 0
    v_mov_b32 v147, 0
    v_mov_b32 v148, 0
    v_mov_b32 v149, 0
    v_mov_b32 v150, 0
    v_mov_b32 v151, 0
    s_mov_b32 s52, s48
    s_mov_b32 s53, s49
    s_mov_b32 s54, 1835008
    s_mov_b32 s55, 131072
    s_mov_b32 s56, s50
    s_mov_b32 s57, s51
    s_mov_b32 s58, 1835008
    s_mov_b32 s59, 131072
    s_and_b32 s44, s2, 4294967288
    s_add_u32 s44, s44, s32
    s_and_b32 s45, s2, 3
    s_mul_i32 s45, s45, 896
    s_add_u32 s38, s44, 0
    s_mul_i32 s38, s38, 3584
    s_add_u32 s38, s38, s45
    buffer_load_dwordx4 v[176:179], v4, s[52:55], s38 offen
    s_add_u32 s38, s44, 256
    s_mul_i32 s38, s38, 3584
    s_add_u32 s38, s38, s45
    buffer_load_dwordx4 v[180:183], v4, s[52:55], s38 offen
    s_add_u32 s38, s44, 0
    s_mul_i32 s38, s38, 3584
    s_add_u32 s38, s38, s45
    buffer_load_dwordx4 v[184:187], v4, s[56:59], s38 offen
    s_add_u32 s38, s44, 256
    s_mul_i32 s38, s38, 3584
    s_add_u32 s38, s38, s45
    buffer_load_dwordx4 v[188:191], v4, s[56:59], s38 offen
    s_add_u32 s24, s4, 8388608
    s_addc_u32 s25, s5, 0
    s_mov_b32 s26, 4194304
    s_mov_b32 s27, 131072
    s_add_u32 s28, s4, 4194304
    s_addc_u32 s29, s5, 0
    s_mov_b32 s30, 131072
    s_mov_b32 s31, 131072
    s_lshl_b32 s38, s41, 10
    v_add_u32 v9, s38, v5
    v_add_u32 v10, s38, v6
    s_waitcnt vmcnt(11)
    s_barrier
    ds_read_b64_tr_b16 v[80:81], v9
    ds_read_b64_tr_b16 v[82:83], v9 offset:512
    ds_read_b64_tr_b16 v[84:85], v9 offset:32768
    ds_read_b64_tr_b16 v[86:87], v9 offset:33280
    ds_read_b64_tr_b16 v[88:89], v10
    ds_read_b64_tr_b16 v[90:91], v10 offset:512
    s_waitcnt vmcnt(10) lgkmcnt(4)
    v_mfma_f32_32x32x16_bf16 v[104:119], v[80:83], v[16:19], v[104:119]
    ds_read_b64_tr_b16 v[92:93], v9 offset:2048
    ds_read_b64_tr_b16 v[94:95], v9 offset:2560
    ds_read_b64_tr_b16 v[96:97], v9 offset:34816
    s_waitcnt lgkmcnt(5)
    v_mfma_f32_32x32x16_bf16 v[120:135], v[84:87], v[16:19], v[120:135]
    ds_read_b64_tr_b16 v[98:99], v9 offset:35328
    ds_read_b64_tr_b16 v[100:101], v10 offset:2048
    s_waitcnt lgkmcnt(5)
    v_mfma_f32_32x32x16_bf16 v[136:151], v[88:91], v[16:19], v[136:151]
    ds_read_b64_tr_b16 v[102:103], v10 offset:2560
    s_add_u32 s38, s37, 8192
    buffer_load_dwordx4 v[32:35], v4, s[12:15], s38 offen
    s_waitcnt vmcnt(10) lgkmcnt(4)
    v_mfma_f32_32x32x16_bf16 v[104:119], v[92:95], v[20:23], v[104:119]
    ds_read_b64_tr_b16 v[80:81], v9 offset:4096
    ds_read_b64_tr_b16 v[82:83], v9 offset:4608
    ds_read_b64_tr_b16 v[84:85], v9 offset:36864
    s_waitcnt lgkmcnt(5)
    v_mfma_f32_32x32x16_bf16 v[120:135], v[96:99], v[20:23], v[120:135]
    ds_read_b64_tr_b16 v[86:87], v9 offset:37376
    ds_read_b64_tr_b16 v[88:89], v10 offset:4096
    s_waitcnt lgkmcnt(5)
    v_mfma_f32_32x32x16_bf16 v[136:151], v[100:103], v[20:23], v[136:151]
    ds_read_b64_tr_b16 v[90:91], v10 offset:4608
    s_add_u32 s38, s37, 10240
    buffer_load_dwordx4 v[36:39], v4, s[12:15], s38 offen
    s_waitcnt vmcnt(10) lgkmcnt(4)
    v_mfma_f32_32x32x16_bf16 v[104:119], v[80:83], v[24:27], v[104:119]
    ds_read_b64_tr_b16 v[92:93], v9 offset:6144
    ds_read_b64_tr_b16 v[94:95], v9 offset:6656
    ds_read_b64_tr_b16 v[96:97], v9 offset:38912
    s_waitcnt lgkmcnt(5)
    v_mfma_f32_32x32x16_bf16 v[120:135], v[84:87], v[24:27], v[120:135]
    ds_read_b64_tr_b16 v[98:99], v9 offset:39424
    ds_read_b64_tr_b16 v[100:101], v10 offset:6144
    s_waitcnt lgkmcnt(5)
    v_mfma_f32_32x32x16_bf16 v[136:151], v[88:91], v[24:27], v[136:151]
    ds_read_b64_tr_b16 v[102:103], v10 offset:6656
    s_add_u32 s38, s37, 12288
    buffer_load_dwordx4 v[40:43], v4, s[12:15], s38 offen
    s_waitcnt vmcnt(10) lgkmcnt(4)
    v_mfma_f32_32x32x16_bf16 v[104:119], v[92:95], v[28:31], v[104:119]
    s_waitcnt vmcnt(7)
    s_barrier
    s_add_u32 s39, s36, 16384
    s_mov_b32 m0, s39
    s_add_u32 s38, s35, 786432
    buffer_load_dwordx4 v3, s[16:19], s38 offen lds
    s_add_u32 s39, s36, 49152
    s_mov_b32 m0, s39
    s_add_u32 s38, s35, 787456
    buffer_load_dwordx4 v3, s[16:19], s38 offen lds
    s_add_u32 s39, s36, 81920
    s_mov_b32 m0, s39
    s_add_u32 s38, s35, 788480
    buffer_load_dwordx4 v3, s[16:19], s38 offen lds
    ds_read_b64_tr_b16 v[80:81], v9 offset:8192
    s_waitcnt lgkmcnt(3)
    v_mfma_f32_32x32x16_bf16 v[120:135], v[96:99], v[28:31], v[120:135]
    ds_read_b64_tr_b16 v[82:83], v9 offset:8704
    ds_read_b64_tr_b16 v[84:85], v9 offset:40960
    ds_read_b64_tr_b16 v[86:87], v9 offset:41472
    s_waitcnt lgkmcnt(4)
    v_mfma_f32_32x32x16_bf16 v[136:151], v[100:103], v[28:31], v[136:151]
    ds_read_b64_tr_b16 v[88:89], v10 offset:8192
    ds_read_b64_tr_b16 v[90:91], v10 offset:8704
    s_add_u32 s38, s37, 14336
    buffer_load_dwordx4 v[44:47], v4, s[12:15], s38 offen
    s_waitcnt vmcnt(6) lgkmcnt(4)
    v_mfma_f32_32x32x16_bf16 v[104:119], v[80:83], v[32:35], v[104:119]
    ds_read_b64_tr_b16 v[92:93], v9 offset:10240
    ds_read_b64_tr_b16 v[94:95], v9 offset:10752
    ds_read_b64_tr_b16 v[96:97], v9 offset:43008
    s_waitcnt lgkmcnt(5)
    v_mfma_f32_32x32x16_bf16 v[120:135], v[84:87], v[32:35], v[120:135]
    ds_read_b64_tr_b16 v[98:99], v9 offset:43520
    ds_read_b64_tr_b16 v[100:101], v10 offset:10240
    s_waitcnt lgkmcnt(5)
    v_mfma_f32_32x32x16_bf16 v[136:151], v[88:91], v[32:35], v[136:151]
    ds_read_b64_tr_b16 v[102:103], v10 offset:10752
    s_add_u32 s38, s37, 16384
    buffer_load_dwordx4 v[48:51], v4, s[12:15], s38 offen
    s_waitcnt vmcnt(6) lgkmcnt(4)
    v_mfma_f32_32x32x16_bf16 v[104:119], v[92:95], v[36:39], v[104:119]
    ds_read_b64_tr_b16 v[80:81], v9 offset:12288
    ds_read_b64_tr_b16 v[82:83], v9 offset:12800
    ds_read_b64_tr_b16 v[84:85], v9 offset:45056
    s_waitcnt lgkmcnt(5)
    v_mfma_f32_32x32x16_bf16 v[120:135], v[96:99], v[36:39], v[120:135]
    ds_read_b64_tr_b16 v[86:87], v9 offset:45568
    ds_read_b64_tr_b16 v[88:89], v10 offset:12288
    s_waitcnt lgkmcnt(5)
    v_mfma_f32_32x32x16_bf16 v[136:151], v[100:103], v[36:39], v[136:151]
    ds_read_b64_tr_b16 v[90:91], v10 offset:12800
    s_add_u32 s38, s37, 18432
    buffer_load_dwordx4 v[52:55], v4, s[12:15], s38 offen
    s_waitcnt vmcnt(6) lgkmcnt(4)
    v_mfma_f32_32x32x16_bf16 v[104:119], v[80:83], v[40:43], v[104:119]
    ds_read_b64_tr_b16 v[92:93], v9 offset:14336
    ds_read_b64_tr_b16 v[94:95], v9 offset:14848
    ds_read_b64_tr_b16 v[96:97], v9 offset:47104
    s_waitcnt lgkmcnt(5)
    v_mfma_f32_32x32x16_bf16 v[120:135], v[84:87], v[40:43], v[120:135]
    ds_read_b64_tr_b16 v[98:99], v9 offset:47616
    ds_read_b64_tr_b16 v[100:101], v10 offset:14336
    s_waitcnt lgkmcnt(5)
    v_mfma_f32_32x32x16_bf16 v[136:151], v[88:91], v[40:43], v[136:151]
    ds_read_b64_tr_b16 v[102:103], v10 offset:14848
    s_add_u32 s38, s37, 20480
    buffer_load_dwordx4 v[56:59], v4, s[12:15], s38 offen
    s_waitcnt vmcnt(3) lgkmcnt(4)
    v_mfma_f32_32x32x16_bf16 v[104:119], v[92:95], v[44:47], v[104:119]
    s_barrier
    s_add_u32 s39, s36, 24576
    s_mov_b32 m0, s39
    s_add_u32 s38, s35, 1179648
    buffer_load_dwordx4 v3, s[16:19], s38 offen lds
    s_add_u32 s39, s36, 57344
    s_mov_b32 m0, s39
    s_add_u32 s38, s35, 1180672
    buffer_load_dwordx4 v3, s[16:19], s38 offen lds
    s_add_u32 s39, s36, 90112
    s_mov_b32 m0, s39
    s_add_u32 s38, s35, 1181696
    buffer_load_dwordx4 v3, s[16:19], s38 offen lds
    ds_read_b64_tr_b16 v[80:81], v9 offset:16384
    s_waitcnt lgkmcnt(3)
    v_mfma_f32_32x32x16_bf16 v[120:135], v[96:99], v[44:47], v[120:135]
    ds_read_b64_tr_b16 v[82:83], v9 offset:16896
    ds_read_b64_tr_b16 v[84:85], v9 offset:49152
    ds_read_b64_tr_b16 v[86:87], v9 offset:49664
    s_waitcnt lgkmcnt(4)
    v_mfma_f32_32x32x16_bf16 v[136:151], v[100:103], v[44:47], v[136:151]
    ds_read_b64_tr_b16 v[88:89], v10 offset:16384
    ds_read_b64_tr_b16 v[90:91], v10 offset:16896
    s_add_u32 s38, s37, 22528
    buffer_load_dwordx4 v[60:63], v4, s[12:15], s38 offen
    s_waitcnt vmcnt(6) lgkmcnt(4)
    v_mfma_f32_32x32x16_bf16 v[104:119], v[80:83], v[48:51], v[104:119]
    ds_read_b64_tr_b16 v[92:93], v9 offset:18432
    ds_read_b64_tr_b16 v[94:95], v9 offset:18944
    ds_read_b64_tr_b16 v[96:97], v9 offset:51200
    s_waitcnt lgkmcnt(5)
    v_mfma_f32_32x32x16_bf16 v[120:135], v[84:87], v[48:51], v[120:135]
    ds_read_b64_tr_b16 v[98:99], v9 offset:51712
    ds_read_b64_tr_b16 v[100:101], v10 offset:18432
    s_waitcnt lgkmcnt(5)
    v_mfma_f32_32x32x16_bf16 v[136:151], v[88:91], v[48:51], v[136:151]
    ds_read_b64_tr_b16 v[102:103], v10 offset:18944
    s_add_u32 s38, s37, 24576
    buffer_load_dwordx4 v[64:67], v4, s[12:15], s38 offen
    s_waitcnt vmcnt(6) lgkmcnt(4)
    v_mfma_f32_32x32x16_bf16 v[104:119], v[92:95], v[52:55], v[104:119]
    ds_read_b64_tr_b16 v[80:81], v9 offset:20480
    ds_read_b64_tr_b16 v[82:83], v9 offset:20992
    ds_read_b64_tr_b16 v[84:85], v9 offset:53248
    s_waitcnt lgkmcnt(5)
    v_mfma_f32_32x32x16_bf16 v[120:135], v[96:99], v[52:55], v[120:135]
    ds_read_b64_tr_b16 v[86:87], v9 offset:53760
    ds_read_b64_tr_b16 v[88:89], v10 offset:20480
    s_waitcnt lgkmcnt(5)
    v_mfma_f32_32x32x16_bf16 v[136:151], v[100:103], v[52:55], v[136:151]
    ds_read_b64_tr_b16 v[90:91], v10 offset:20992
    s_add_u32 s38, s37, 26624
    buffer_load_dwordx4 v[68:71], v4, s[12:15], s38 offen
    s_waitcnt vmcnt(6) lgkmcnt(4)
    v_mfma_f32_32x32x16_bf16 v[104:119], v[80:83], v[56:59], v[104:119]
    ds_read_b64_tr_b16 v[92:93], v9 offset:22528
    ds_read_b64_tr_b16 v[94:95], v9 offset:23040
    ds_read_b64_tr_b16 v[96:97], v9 offset:55296
    s_waitcnt lgkmcnt(5)
    v_mfma_f32_32x32x16_bf16 v[120:135], v[84:87], v[56:59], v[120:135]
    ds_read_b64_tr_b16 v[98:99], v9 offset:55808
    ds_read_b64_tr_b16 v[100:101], v10 offset:22528
    s_waitcnt lgkmcnt(5)
    v_mfma_f32_32x32x16_bf16 v[136:151], v[88:91], v[56:59], v[136:151]
    ds_read_b64_tr_b16 v[102:103], v10 offset:23040
    s_add_u32 s38, s37, 28672
    buffer_load_dwordx4 v[72:75], v4, s[12:15], s38 offen
    s_waitcnt vmcnt(3) lgkmcnt(4)
    v_mfma_f32_32x32x16_bf16 v[104:119], v[92:95], v[60:63], v[104:119]
    s_barrier
    ds_read_b64_tr_b16 v[80:81], v9 offset:24576
    ds_read_b64_tr_b16 v[82:83], v9 offset:25088
    s_waitcnt lgkmcnt(4)
    v_mfma_f32_32x32x16_bf16 v[120:135], v[96:99], v[60:63], v[120:135]
    ds_read_b64_tr_b16 v[84:85], v9 offset:57344
    ds_read_b64_tr_b16 v[86:87], v9 offset:57856
    ds_read_b64_tr_b16 v[88:89], v10 offset:24576
    s_waitcnt lgkmcnt(5)
    v_mfma_f32_32x32x16_bf16 v[136:151], v[100:103], v[60:63], v[136:151]
    ds_read_b64_tr_b16 v[90:91], v10 offset:25088
    s_add_u32 s38, s37, 30720
    buffer_load_dwordx4 v[76:79], v4, s[12:15], s38 offen
    s_waitcnt vmcnt(3) lgkmcnt(4)
    v_mfma_f32_32x32x16_bf16 v[104:119], v[80:83], v[64:67], v[104:119]
    ds_read_b64_tr_b16 v[92:93], v9 offset:26624
    ds_read_b64_tr_b16 v[94:95], v9 offset:27136
    s_waitcnt lgkmcnt(4)
    v_mfma_f32_32x32x16_bf16 v[120:135], v[84:87], v[64:67], v[120:135]
    ds_read_b64_tr_b16 v[96:97], v9 offset:59392
    ds_read_b64_tr_b16 v[98:99], v9 offset:59904
    s_waitcnt lgkmcnt(4)
    v_mfma_f32_32x32x16_bf16 v[136:151], v[88:91], v[64:67], v[136:151]
    ds_read_b64_tr_b16 v[100:101], v10 offset:26624
    ds_read_b64_tr_b16 v[102:103], v10 offset:27136
    s_waitcnt vmcnt(2) lgkmcnt(4)
    v_mfma_f32_32x32x16_bf16 v[104:119], v[92:95], v[68:71], v[104:119]
    ds_read_b64_tr_b16 v[80:81], v9 offset:28672
    ds_read_b64_tr_b16 v[82:83], v9 offset:29184
    s_waitcnt lgkmcnt(4)
    v_mfma_f32_32x32x16_bf16 v[120:135], v[96:99], v[68:71], v[120:135]
    ds_read_b64_tr_b16 v[84:85], v9 offset:61440
    ds_read_b64_tr_b16 v[86:87], v9 offset:61952
    s_waitcnt lgkmcnt(4)
    v_mfma_f32_32x32x16_bf16 v[136:151], v[100:103], v[68:71], v[136:151]
    ds_read_b64_tr_b16 v[88:89], v10 offset:28672
    ds_read_b64_tr_b16 v[90:91], v10 offset:29184
    s_waitcnt vmcnt(1) lgkmcnt(4)
    v_mfma_f32_32x32x16_bf16 v[104:119], v[80:83], v[72:75], v[104:119]
    ds_read_b64_tr_b16 v[92:93], v9 offset:30720
    ds_read_b64_tr_b16 v[94:95], v9 offset:31232
    s_waitcnt lgkmcnt(4)
    v_mfma_f32_32x32x16_bf16 v[120:135], v[84:87], v[72:75], v[120:135]
    ds_read_b64_tr_b16 v[96:97], v9 offset:63488
    ds_read_b64_tr_b16 v[98:99], v9 offset:64000
    s_waitcnt lgkmcnt(4)
    v_mfma_f32_32x32x16_bf16 v[136:151], v[88:91], v[72:75], v[136:151]
    ds_read_b64_tr_b16 v[100:101], v10 offset:30720
    ds_read_b64_tr_b16 v[102:103], v10 offset:31232
    s_waitcnt vmcnt(0) lgkmcnt(4)
    v_mfma_f32_32x32x16_bf16 v[104:119], v[92:95], v[76:79], v[104:119]
    s_waitcnt lgkmcnt(2)
    v_mfma_f32_32x32x16_bf16 v[120:135], v[96:99], v[76:79], v[120:135]
    s_waitcnt lgkmcnt(0)
    v_mfma_f32_32x32x16_bf16 v[136:151], v[100:103], v[76:79], v[136:151]
    s_barrier
    v_lshl_add_u32 v11, v2, 13, v4
    s_nop 15
    s_cmp_eq_u32 s41, 0
    s_cbranch_scc1 k1_qkv_kernel_x0
    ds_write_b128 v11, v[104:107]
    ds_write_b128 v11, v[108:111] offset:1024
    ds_write_b128 v11, v[120:123] offset:2048
    ds_write_b128 v11, v[124:127] offset:3072
    ds_write_b128 v11, v[136:139] offset:4096
    ds_write_b128 v11, v[140:143] offset:5120
    v_mov_b32 v16, v112
    v_mov_b32 v17, v113
    v_mov_b32 v18, v114
    v_mov_b32 v19, v115
    v_mov_b32 v20, v116
    v_mov_b32 v21, v117
    v_mov_b32 v22, v118
    v_mov_b32 v23, v119
    v_mov_b32 v24, v128
    v_mov_b32 v25, v129
    v_mov_b32 v26, v130
    v_mov_b32 v27, v131
    v_mov_b32 v28, v132
    v_mov_b32 v29, v133
    v_mov_b32 v30, v134
    v_mov_b32 v31, v135
    v_mov_b32 v32, v144
    v_mov_b32 v33, v145
    v_mov_b32 v34, v146
    v_mov_b32 v35, v147
    v_mov_b32 v36, v148
    v_mov_b32 v37, v149
    v_mov_b32 v38, v150
    v_mov_b32 v39, v151
    s_nop 15
    s_branch k1_qkv_kernel_x1
k1_qkv_kernel_x0:
    ds_write_b128 v11, v[112:115]
    ds_write_b128 v11, v[116:119] offset:1024
    ds_write_b128 v11, v[128:131] offset:2048
    ds_write_b128 v11, v[132:135] offset:3072
    ds_write_b128 v11, v[144:147] offset:4096
    ds_write_b128 v11, v[148:151] offset:5120
    v_mov_b32 v16, v104
    v_mov_b32 v17, v105
    v_mov_b32 v18, v106
    v_mov_b32 v19, v107
    v_mov_b32 v20, v108
    v_mov_b32 v21, v109
    v_mov_b32 v22, v110
    v_mov_b32 v23, v111
    v_mov_b32 v24, v120
    v_mov_b32 v25, v121
    v_mov_b32 v26, v122
    v_mov_b32 v27, v123
    v_mov_b32 v28, v124
    v_mov_b32 v29, v125
    v_mov_b32 v30, v126
    v_mov_b32 v31, v127
    v_mov_b32 v32, v136
    v_mov_b32 v33, v137
    v_mov_b32 v34, v138
    v_mov_b32 v35, v139
    v_mov_b32 v36, v140
    v_mov_b32 v37, v141
    v_mov_b32 v38, v142
    v_mov_b32 v39, v143
    s_nop 15
k1_qkv_kernel_x1:
    s_waitcnt lgkmcnt(0)
    s_barrier
    v_xor_b32 v12, 32768, v11
    ds_read_b128 v[40:43], v12
    ds_read_b128 v[44:47], v12 offset:1024
    ds_read_b128 v[48:51], v12 offset:2048
    ds_read_b128 v[52:55], v12 offset:3072
    ds_read_b128 v[56:59], v12 offset:4096
    ds_read_b128 v[60:63], v12 offset:5120
    s_waitcnt lgkmcnt(5)
    v_add_f32 v16, v16, v40
    v_add_f32 v17, v17, v41
    v_add_f32 v18, v18, v42
    v_add_f32 v19, v19, v43
    s_waitcnt lgkmcnt(4)
    v_add_f32 v20, v20, v44
    v_add_f32 v21, v21, v45
    v_add_f32 v22, v22, v46
    v_add_f32 v23, v23, v47
    s_waitcnt lgkmcnt(3)
    v_add_f32 v24, v24, v48
    v_add_f32 v25, v25, v49
    v_add_f32 v26, v26, v50
    v_add_f32 v27, v27, v51
    s_waitcnt lgkmcnt(2)
    v_add_f32 v28, v28, v52
    v_add_f32 v29, v29, v53
    v_add_f32 v30, v30, v54
    v_add_f32 v31, v31, v55
    s_waitcnt lgkmcnt(1)
    v_add_f32 v32, v32, v56
    v_add_f32 v33, v33, v57
    v_add_f32 v34, v34, v58
    v_add_f32 v35, v35, v59
    s_waitcnt lgkmcnt(0)
    v_add_f32 v36, v36, v60
    v_add_f32 v37, v37, v61
    v_add_f32 v38, v38, v62
    v_add_f32 v39, v39, v63
    s_barrier
    s_mov_b32 s42, 1069066811
    s_mov_b32 s43, 3216550459
    v_lshrrev_b32 v7, 5, v1
    v_lshlrev_b32 v7, 2, v7
    v_bfe_u32 v8, v1, 2, 2
    v_add_u32 v7, v7, v8
    v_lshlrev_b32 v13, 5, v7
    v_bfe_u32 v7, v1, 4, 1
    v_mul_u32_u24 v7, 0, v7
    v_add_u32 v13, v13, v7
    v_and_b32 v8, 3, v1
    v_lshl_add_u32 v13, v8, 3, v13
    s_lshl_b32 s38, s41, 9
    v_add_u32 v13, s38, v13
    v_add_u32 v13, 98304, v13
    v_and_b32 v7, 16, v1
    v_lshlrev_b32 v7, 27, v7
    v_lshrrev_b32 v8, 16, v7
    v_or_b32 v14, v7, v8
    ds_read_b64_tr_b16 v[64:65], v13
    ds_read_b64_tr_b16 v[66:67], v13 offset:256
    s_waitcnt lgkmcnt(1)
    v_xor_b32 v64, v64, v14
    v_xor_b32 v65, v65, v14
    s_waitcnt lgkmcnt(0)
    v_xor_b32 v66, v66, v14
    v_xor_b32 v67, v67, v14
    v_cvt_pk_bf16_f32 v68, v16, v17
    v_cvt_pk_bf16_f32 v69, v18, v19
    v_cvt_pk_bf16_f32 v70, v20, v21
    v_cvt_pk_bf16_f32 v71, v22, v23
    v_cvt_pk_bf16_f32 v72, v24, v25
    v_cvt_pk_bf16_f32 v73, v26, v27
    v_cvt_pk_bf16_f32 v74, v28, v29
    v_cvt_pk_bf16_f32 v75, v30, v31
    v_mfma_f32_32x32x16_bf16 v[152:167], v[64:67], v[68:71], 0
    s_nop 0
    v_mfma_f32_32x32x16_bf16 v[168:183], v[64:67], v[72:75], 0
    s_nop 9
    v_max3_f32 v184, v152, v153, v154
    v_max3_f32 v186, v160, v161, v162
    v_max3_f32 v188, v168, v169, v170
    v_max3_f32 v190, v176, v177, v178
    v_max3_f32 v184, v184, v155, v156
    v_max3_f32 v186, v186, v163, v164
    v_max3_f32 v188, v188, v171, v172
    v_max3_f32 v190, v190, v179, v180
    v_max3_f32 v184, v184, v157, v158
    v_max3_f32 v186, v186, v165, v166
    v_max3_f32 v188, v188, v173, v174
    v_max3_f32 v190, v190, v181, v182
    v_max_f32 v184, v184, v159
    v_max_f32 v186, v186, v167
    v_max_f32 v188, v188, v175
    v_max_f32 v190, v190, v183
    v_mov_b32 v185, v184
    v_mov_b32 v187, v186
    v_mov_b32 v189, v188
    v_mov_b32 v191, v190
    v_permlane32_swap_b32 v184, v185
    v_permlane32_swap_b32 v186, v187
    v_permlane32_swap_b32 v188, v189
    v_permlane32_swap_b32 v190, v191
    v_max_f32 v184, v184, v185
    v_max_f32 v186, v186, v187
    v_max_f32 v188, v188, v189
    v_max_f32 v190, v190, v191
    v_mul_f32 v184, s43, v184
    v_mul_f32 v186, s43, v186
    v_mul_f32 v188, s43, v188
    v_mul_f32 v190, s43, v190
    v_fma_f32 v152, v152, s42, v184
    v_fma_f32 v160, v160, s42, v186
    v_fma_f32 v168, v168, s42, v188
    v_fma_f32 v176, v176, s42, v190
    v_fma_f32 v153, v153, s42, v184
    v_fma_f32 v161, v161, s42, v186
    v_fma_f32 v169, v169, s42, v188
    v_fma_f32 v177, v177, s42, v190
    v_fma_f32 v154, v154, s42, v184
    v_fma_f32 v162, v162, s42, v186
    v_fma_f32 v170, v170, s42, v188
    v_fma_f32 v178, v178, s42, v190
    v_fma_f32 v155, v155, s42, v184
    v_fma_f32 v163, v163, s42, v186
    v_fma_f32 v171, v171, s42, v188
    v_fma_f32 v179, v179, s42, v190
    v_fma_f32 v156, v156, s42, v184
    v_fma_f32 v164, v164, s42, v186
    v_fma_f32 v172, v172, s42, v188
    v_fma_f32 v180, v180, s42, v190
    v_fma_f32 v157, v157, s42, v184
    v_fma_f32 v165, v165, s42, v186
    v_fma_f32 v173, v173, s42, v188
    v_fma_f32 v181, v181, s42, v190
    v_fma_f32 v158, v158, s42, v184
    v_fma_f32 v166, v166, s42, v186
    v_fma_f32 v174, v174, s42, v188
    v_fma_f32 v182, v182, s42, v190
    v_fma_f32 v159, v159, s42, v184
    v_fma_f32 v167, v167, s42, v186
    v_fma_f32 v175, v175, s42, v188
    v_fma_f32 v183, v183, s42, v190
    v_exp_f32 v152, v152
    v_exp_f32 v160, v160
    v_exp_f32 v168, v168
    v_exp_f32 v176, v176
    v_exp_f32 v153, v153
    v_exp_f32 v161, v161
    v_exp_f32 v169, v169
    v_exp_f32 v177, v177
    v_exp_f32 v154, v154
    v_exp_f32 v162, v162
    v_exp_f32 v170, v170
    v_exp_f32 v178, v178
    v_exp_f32 v155, v155
    v_exp_f32 v163, v163
    v_exp_f32 v171, v171
    v_exp_f32 v179, v179
    v_exp_f32 v156, v156
    v_exp_f32 v164, v164
    v_exp_f32 v172, v172
    v_exp_f32 v180, v180
    v_exp_f32 v157, v157
    v_exp_f32 v165, v165
    v_exp_f32 v173, v173
    v_exp_f32 v181, v181
    v_exp_f32 v158, v158
    v_exp_f32 v166, v166
    v_exp_f32 v174, v174
    v_exp_f32 v182, v182
    v_exp_f32 v159, v159
    v_exp_f32 v167, v167
    v_exp_f32 v175, v175
    v_exp_f32 v183, v183
    v_add_f32 v184, v152, v153
    v_add_f32 v186, v160, v161
    v_add_f32 v188, v168, v169
    v_add_f32 v190, v176, v177
    v_add_f32 v184, v184, v154
    v_add_f32 v186, v186, v162
    v_add_f32 v188, v188, v170
    v_add_f32 v190, v190, v178
    v_add_f32 v184, v184, v155
    v_add_f32 v186, v186, v163
    v_add_f32 v188, v188, v171
    v_add_f32 v190, v190, v179
    v_add_f32 v184, v184, v156
    v_add_f32 v186, v186, v164
    v_add_f32 v188, v188, v172
    v_add_f32 v190, v190, v180
    v_add_f32 v184, v184, v157
    v_add_f32 v186, v186, v165
    v_add_f32 v188, v188, v173
    v_add_f32 v190, v190, v181
    v_add_f32 v184, v184, v158
    v_add_f32 v186, v186, v166
    v_add_f32 v188, v188, v174
    v_add_f32 v190, v190, v182
    v_add_f32 v184, v184, v159
    v_add_f32 v186, v186, v167
    v_add_f32 v188, v188, v175
    v_add_f32 v190, v190, v183
    v_mov_b32 v185, v184
    v_mov_b32 v187, v186
    v_mov_b32 v189, v188
    v_mov_b32 v191, v190
    v_permlane32_swap_b32 v184, v185
    v_permlane32_swap_b32 v186, v187
    v_permlane32_swap_b32 v188, v189
    v_permlane32_swap_b32 v190, v191
    v_add_f32 v184, v184, v185
    v_add_f32 v186, v186, v187
    v_add_f32 v188, v188, v189
    v_add_f32 v190, v190, v191
    v_rcp_f32 v184, v184
    v_rcp_f32 v186, v186
    v_rcp_f32 v188, v188
    v_rcp_f32 v190, v190
    v_mul_f32 v152, v152, v184
    v_mul_f32 v160, v160, v186
    v_mul_f32 v168, v168, v188
    v_mul_f32 v176, v176, v190
    v_mul_f32 v153, v153, v184
    v_mul_f32 v161, v161, v186
    v_mul_f32 v169, v169, v188
    v_mul_f32 v177, v177, v190
    v_mul_f32 v154, v154, v184
    v_mul_f32 v162, v162, v186
    v_mul_f32 v170, v170, v188
    v_mul_f32 v178, v178, v190
    v_mul_f32 v155, v155, v184
    v_mul_f32 v163, v163, v186
    v_mul_f32 v171, v171, v188
    v_mul_f32 v179, v179, v190
    v_mul_f32 v156, v156, v184
    v_mul_f32 v164, v164, v186
    v_mul_f32 v172, v172, v188
    v_mul_f32 v180, v180, v190
    v_mul_f32 v157, v157, v184
    v_mul_f32 v165, v165, v186
    v_mul_f32 v173, v173, v188
    v_mul_f32 v181, v181, v190
    v_mul_f32 v158, v158, v184
    v_mul_f32 v166, v166, v186
    v_mul_f32 v174, v174, v188
    v_mul_f32 v182, v182, v190
    v_mul_f32 v159, v159, v184
    v_mul_f32 v167, v167, v186
    v_mul_f32 v175, v175, v188
    v_mul_f32 v183, v183, v190
    v_cvt_pk_bf16_f32 v192, v152, v153
    v_cvt_pk_bf16_f32 v196, v160, v161
    v_cvt_pk_bf16_f32 v200, v168, v169
    v_cvt_pk_bf16_f32 v204, v176, v177
    v_cvt_pk_bf16_f32 v193, v154, v155
    v_cvt_pk_bf16_f32 v197, v162, v163
    v_cvt_pk_bf16_f32 v201, v170, v171
    v_cvt_pk_bf16_f32 v205, v178, v179
    v_cvt_pk_bf16_f32 v194, v156, v157
    v_cvt_pk_bf16_f32 v198, v164, v165
    v_cvt_pk_bf16_f32 v202, v172, v173
    v_cvt_pk_bf16_f32 v206, v180, v181
    v_cvt_pk_bf16_f32 v195, v158, v159
    v_cvt_pk_bf16_f32 v199, v166, v167
    v_cvt_pk_bf16_f32 v203, v174, v175
    v_cvt_pk_bf16_f32 v207, v182, v183
    s_lshl_b32 s38, s33, 2
    s_add_u32 s38, s38, s40
    s_lshl_b32 s38, s38, 5
    s_lshl_b32 s39, s34, 1
    s_add_u32 s38, s38, s39
    s_add_u32 s38, s38, s41
    s_lshl_b32 s38, s38, 11
    buffer_store_dwordx4 v[192:195], v4, s[24:27], s38 offen
    buffer_store_dwordx4 v[196:199], v4, s[24:27], s38 offen offset:1024
    v_and_b32 v7, 31, v1
    s_lshl_b32 s38, s40, 5
    v_add_u32 v7, s38, v7
    v_mul_u32_u24 v15, 72, v7
    v_lshrrev_b32 v8, 5, v1
    v_lshl_add_u32 v15, v8, 3, v15
    s_mul_i32 s38, s41, 9216
    v_add_u32 v15, s38, v15
    v_add_u32 v213, 67584, v15
    v_add_u32 v15, 49152, v15
    ds_write_b64 v15, v[200:201]
    ds_write_b64 v15, v[202:203] offset:16
    ds_write_b64 v15, v[204:205] offset:32
    ds_write_b64 v15, v[206:207] offset:48
    v_cvt_pk_bf16_f32 v208, v32, v33
    v_cvt_pk_bf16_f32 v209, v34, v35
    v_cvt_pk_bf16_f32 v210, v36, v37
    v_cvt_pk_bf16_f32 v211, v38, v39
    ds_write_b64 v213, v[208:209]
    ds_write_b64 v213, v[210:211] offset:16
    v_mov_b32 v212, 16256
    v_cmp_eq_u32 vcc, 0, v8
    s_nop 1
    v_cndmask_b32 v212, 0, v212, vcc
    ds_write_b32 v213, v212 offset:32
    s_waitcnt lgkmcnt(0)
    s_barrier
    s_nop 15
    s_cmp_ge_u32 s32, 2
    s_cbranch_scc1 k1_qkv_kernel_end
    v_lshrrev_b32 v7, 5, v1
    v_lshlrev_b32 v7, 2, v7
    v_bfe_u32 v8, v1, 2, 2
    v_add_u32 v7, v7, v8
    v_mul_u32_u24 v13, 72, v7
    v_bfe_u32 v7, v1, 4, 1
    v_lshl_add_u32 v13, v7, 5, v13
    v_and_b32 v8, 3, v1
    v_lshl_add_u32 v13, v8, 3, v13
    s_mul_i32 s38, s32, 9216
    v_add_u32 v13, s38, v13
    v_add_u32 v14, 67584, v13
    v_add_u32 v13, 49152, v13
    ds_read_b64_tr_b16 v[32:33], v14
    ds_read_b64_tr_b16 v[36:37], v13
    ds_read_b64_tr_b16 v[34:35], v14 offset:576
    ds_read_b64_tr_b16 v[38:39], v13 offset:576
    ds_read_b64_tr_b16 v[40:41], v14 offset:1152
    ds_read_b64_tr_b16 v[44:45], v13 offset:1152
    ds_read_b64_tr_b16 v[42:43], v14 offset:1728
    ds_read_b64_tr_b16 v[46:47], v13 offset:1728
    s_waitcnt lgkmcnt(4)
    v_mfma_f32_32x32x16_bf16 v[16:31], v[32:35], v[36:39], 0
    ds_read_b64_tr_b16 v[32:33], v14 offset:2304
    ds_read_b64_tr_b16 v[36:37], v13 offset:2304
    ds_read_b64_tr_b16 v[34:35], v14 offset:2880
    ds_read_b64_tr_b16 v[38:39], v13 offset:2880
    s_waitcnt lgkmcnt(4)
    v_mfma_f32_32x32x16_bf16 v[16:31], v[40:43], v[44:47], v[16:31]
    ds_read_b64_tr_b16 v[40:41], v14 offset:3456
    ds_read_b64_tr_b16 v[44:45], v13 offset:3456
    ds_read_b64_tr_b16 v[42:43], v14 offset:4032
    ds_read_b64_tr_b16 v[46:47], v13 offset:4032
    s_waitcnt lgkmcnt(4)
    v_mfma_f32_32x32x16_bf16 v[16:31], v[32:35], v[36:39], v[16:31]
    ds_read_b64_tr_b16 v[32:33], v14 offset:4608
    ds_read_b64_tr_b16 v[36:37], v13 offset:4608
    ds_read_b64_tr_b16 v[34:35], v14 offset:5184
    ds_read_b64_tr_b16 v[38:39], v13 offset:5184
    s_waitcnt lgkmcnt(4)
    v_mfma_f32_32x32x16_bf16 v[16:31], v[40:43], v[44:47], v[16:31]
    ds_read_b64_tr_b16 v[40:41], v14 offset:5760
    ds_read_b64_tr_b16 v[44:45], v13 offset:5760
    ds_read_b64_tr_b16 v[42:43], v14 offset:6336
    ds_read_b64_tr_b16 v[46:47], v13 offset:6336
    s_waitcnt lgkmcnt(4)
    v_mfma_f32_32x32x16_bf16 v[16:31], v[32:35], v[36:39], v[16:31]
    ds_read_b64_tr_b16 v[32:33], v14 offset:6912
    ds_read_b64_tr_b16 v[36:37], v13 offset:6912
    ds_read_b64_tr_b16 v[34:35], v14 offset:7488
    ds_read_b64_tr_b16 v[38:39], v13 offset:7488
    s_waitcnt lgkmcnt(4)
    v_mfma_f32_32x32x16_bf16 v[16:31], v[40:43], v[44:47], v[16:31]
    ds_read_b64_tr_b16 v[40:41], v14 offset:8064
    ds_read_b64_tr_b16 v[44:45], v13 offset:8064
    ds_read_b64_tr_b16 v[42:43], v14 offset:8640
    ds_read_b64_tr_b16 v[46:47], v13 offset:8640
    s_waitcnt lgkmcnt(4)
    v_mfma_f32_32x32x16_bf16 v[16:31], v[32:35], v[36:39], v[16:31]
    s_waitcnt lgkmcnt(0)
    v_mfma_f32_32x32x16_bf16 v[16:31], v[40:43], v[44:47], v[16:31]
    v_and_b32 v7, 31, v1
    v_lshlrev_b32 v15, 2, v7
    v_lshrrev_b32 v8, 5, v1
    v_lshl_add_u32 v15, v8, 9, v15
    s_lshl_b32 s38, s34, 1
    s_add_u32 s38, s38, s32
    s_lshl_b32 s38, s38, 12
    s_nop 4
    buffer_atomic_add_f32 v16, v15, s[28:31], s38 offen
    buffer_atomic_add_f32 v17, v15, s[28:31], s38 offen offset:128
    buffer_atomic_add_f32 v18, v15, s[28:31], s38 offen offset:256
    buffer_atomic_add_f32 v19, v15, s[28:31], s38 offen offset:384
    buffer_atomic_add_f32 v20, v15, s[28:31], s38 offen offset:1024
    buffer_atomic_add_f32 v21, v15, s[28:31], s38 offen offset:1152
    buffer_atomic_add_f32 v22, v15, s[28:31], s38 offen offset:1280
    buffer_atomic_add_f32 v23, v15, s[28:31], s38 offen offset:1408
    s_mov_b32 exec_hi, 0
    buffer_atomic_add_f32 v24, v15, s[28:31], s38 offen offset:2048
    s_mov_b32 exec_hi, -1
k1_qkv_kernel_end:
    s_endpgm
.globl k2_attn_kernel
.p2align 8
.type k2_attn_kernel,@function
k2_attn_kernel:
    s_cmp_ge_u32 s2, 256
    s_cbranch_scc1 k2_attn_kernel_end
    s_load_dwordx2 s[4:5], s[0:1], 80
    s_load_dwordx2 s[6:7], s[0:1], 24
    s_load_dwordx2 s[50:51], s[0:1], 56
    v_and_b32 v1, 63, v0
    v_lshrrev_b32 v2, 6, v0
    s_nop 0
    v_readfirstlane_b32 s36, v2
    s_lshr_b32 s37, s2, 5
    s_and_b32 s38, s2, 31
    v_lshrrev_b32 v8, 2, v1
    v_lshlrev_b32 v3, 10, v8
    v_and_b32 v9, 3, v1
    v_lshl_add_u32 v3, v9, 4, v3
    v_lshlrev_b32 v4, 4, v1
    v_lshrrev_b32 v8, 5, v1
    v_lshlrev_b32 v8, 2, v8
    v_bfe_u32 v9, v1, 2, 2
    v_add_u32 v8, v8, v9
    v_lshlrev_b32 v5, 6, v8
    v_bfe_u32 v8, v1, 4, 1
    v_lshl_add_u32 v5, v8, 5, v5
    v_and_b32 v9, 3, v1
    v_lshl_add_u32 v5, v9, 3, v5
    v_add_u32 v5, 65536, v5
    v_and_b32 v8, 31, v1
    v_min_u32 v8, 16, v8
    v_lshlrev_b32 v6, 7, v8
    v_lshrrev_b32 v9, 5, v1
    v_lshl_add_u32 v6, v9, 4, v6
    v_lshl_add_u32 v7, v2, 13, v4
    s_waitcnt lgkmcnt(0)
    s_add_u32 s12, s4, 4194304
    s_addc_u32 s13, s5, 0
    s_mov_b32 s14, 131072
    s_mov_b32 s15, 131072
    s_mov_b32 s16, s6
    s_mov_b32 s17, s7
    s_mov_b32 s18, 524288
    s_mov_b32 s19, 131072
    s_add_u32 s8, s4, 8388608
    s_addc_u32 s9, s5, 0
    s_mov_b32 s10, 4194304
    s_mov_b32 s11, 131072
    s_and_b32 s39, s36, 1
    s_lshr_b32 s40, s36, 1
    s_lshl_b32 s41, s38, 1
    s_add_u32 s41, s41, s39
    s_lshl_b32 s46, s36, 14
    s_add_u32 s42, s46, 0
    buffer_load_dwordx4 v[32:35], v6, s[12:15], s42 offen
    buffer_load_dwordx4 v[36:39], v6, s[12:15], s42 offen offset:32
    buffer_load_dwordx4 v[40:43], v6, s[12:15], s42 offen offset:64
    buffer_load_dwordx4 v[44:47], v6, s[12:15], s42 offen offset:96
    s_add_u32 s42, s46, 4096
    buffer_load_dwordx4 v[48:51], v6, s[12:15], s42 offen
    buffer_load_dwordx4 v[52:55], v6, s[12:15], s42 offen offset:32
    buffer_load_dwordx4 v[56:59], v6, s[12:15], s42 offen offset:64
    buffer_load_dwordx4 v[60:63], v6, s[12:15], s42 offen offset:96
    s_add_u32 s42, s46, 8192
    buffer_load_dwordx4 v[64:67], v6, s[12:15], s42 offen
    buffer_load_dwordx4 v[68:71], v6, s[12:15], s42 offen offset:32
    buffer_load_dwordx4 v[72:75], v6, s[12:15], s42 offen offset:64
    buffer_load_dwordx4 v[76:79], v6, s[12:15], s42 offen offset:96
    s_add_u32 s42, s46, 12288
    buffer_load_dwordx4 v[80:83], v6, s[12:15], s42 offen
    buffer_load_dwordx4 v[84:87], v6, s[12:15], s42 offen offset:32
    buffer_load_dwordx4 v[88:91], v6, s[12:15], s42 offen offset:64
    buffer_load_dwordx4 v[92:95], v6, s[12:15], s42 offen offset:96
    s_lshl_b32 s44, s36, 16
    s_lshl_b32 s42, s37, 7
    s_add_u32 s44, s44, s42
    s_lshl_b32 s45, s36, 12
    s_add_u32 s43, s45, 65536
    s_mov_b32 m0, s43
    s_add_u32 s42, s44, 0
    buffer_load_dwordx4 v3, s[16:19], s42 offen lds
    s_add_u32 s43, s45, 98304
    s_mov_b32 m0, s43
    s_add_u32 s42, s44, 64
    buffer_load_dwordx4 v3, s[16:19], s42 offen lds
    s_add_u32 s43, s45, 66560
    s_mov_b32 m0, s43
    s_add_u32 s42, s44, 16384
    buffer_load_dwordx4 v3, s[16:19], s42 offen lds
    s_add_u32 s43, s45, 99328
    s_mov_b32 m0, s43
    s_add_u32 s42, s44, 16448
    buffer_load_dwordx4 v3, s[16:19], s42 offen lds
    s_add_u32 s43, s45, 67584
    s_mov_b32 m0, s43
    s_add_u32 s42, s44, 32768
    buffer_load_dwordx4 v3, s[16:19], s42 offen lds
    s_add_u32 s43, s45, 100352
    s_mov_b32 m0, s43
    s_add_u32 s42, s44, 32832
    buffer_load_dwordx4 v3, s[16:19], s42 offen lds
    s_add_u32 s43, s45, 68608
    s_mov_b32 m0, s43
    s_add_u32 s42, s44, 49152
    buffer_load_dwordx4 v3, s[16:19], s42 offen lds
    s_add_u32 s43, s45, 101376
    s_mov_b32 m0, s43
    s_add_u32 s42, s44, 49216
    buffer_load_dwordx4 v3, s[16:19], s42 offen lds
    s_lshl_b32 s47, s41, 5
    s_lshl_b32 s42, s40, 3
    s_add_u32 s47, s47, s42
    s_lshl_b32 s47, s47, 11
    s_add_u32 s42, s47, 0
    buffer_load_dwordx4 v[96:99], v4, s[8:11], s42 offen
    buffer_load_dwordx4 v[100:103], v4, s[8:11], s42 offen offset:1024
    s_add_u32 s42, s47, 2048
    buffer_load_dwordx4 v[104:107], v4, s[8:11], s42 offen
    buffer_load_dwordx4 v[108:111], v4, s[8:11], s42 offen offset:1024
    s_add_u32 s20, s4, 2097152
    s_addc_u32 s21, s5, 0
    s_mov_b32 s22, 2097152
    s_mov_b32 s23, 131072
    s_lshl_b32 s48, s41, 5
    s_lshl_b32 s42, s37, 2
    s_add_u32 s48, s48, s42
    s_add_u32 s48, s48, s40
    s_lshl_b32 s48, s48, 10
    buffer_load_dwordx4 v[24:27], v4, s[20:23], s48 offen
    s_add_u32 s24, s4, 12582912
    s_addc_u32 s25, s5, 0
    s_mov_b32 s26, 2097152
    s_mov_b32 s27, 131072
    s_add_u32 s28, s4, 14680064
    s_addc_u32 s29, s5, 0
    s_mov_b32 s30, 131072
    s_mov_b32 s31, 131072
    s_waitcnt vmcnt(28)
    v_cvt_pk_bf16_f32 v128, v32, v33
    v_cvt_pk_bf16_f32 v129, v34, v35
    s_waitcnt vmcnt(27)
    v_cvt_pk_bf16_f32 v130, v36, v37
    v_cvt_pk_bf16_f32 v131, v38, v39
    ds_write_b128 v7, v[128:131]
    s_waitcnt vmcnt(26)
    v_cvt_pk_bf16_f32 v132, v40, v41
    v_cvt_pk_bf16_f32 v133, v42, v43
    s_waitcnt vmcnt(25)
    v_cvt_pk_bf16_f32 v134, v44, v45
    v_cvt_pk_bf16_f32 v135, v46, v47
    ds_write_b128 v7, v[132:135] offset:1024
    s_waitcnt vmcnt(24)
    v_cvt_pk_bf16_f32 v136, v48, v49
    v_cvt_pk_bf16_f32 v137, v50, v51
    s_waitcnt vmcnt(23)
    v_cvt_pk_bf16_f32 v138, v52, v53
    v_cvt_pk_bf16_f32 v139, v54, v55
    ds_write_b128 v7, v[136:139] offset:2048
    s_waitcnt vmcnt(22)
    v_cvt_pk_bf16_f32 v140, v56, v57
    v_cvt_pk_bf16_f32 v141, v58, v59
    s_waitcnt vmcnt(21)
    v_cvt_pk_bf16_f32 v142, v60, v61
    v_cvt_pk_bf16_f32 v143, v62, v63
    ds_write_b128 v7, v[140:143] offset:3072
    s_waitcnt vmcnt(20)
    v_cvt_pk_bf16_f32 v144, v64, v65
    v_cvt_pk_bf16_f32 v145, v66, v67
    s_waitcnt vmcnt(19)
    v_cvt_pk_bf16_f32 v146, v68, v69
    v_cvt_pk_bf16_f32 v147, v70, v71
    ds_write_b128 v7, v[144:147] offset:4096
    s_waitcnt vmcnt(18)
    v_cvt_pk_bf16_f32 v148, v72, v73
    v_cvt_pk_bf16_f32 v149, v74, v75
    s_waitcnt vmcnt(17)
    v_cvt_pk_bf16_f32 v150, v76, v77
    v_cvt_pk_bf16_f32 v151, v78, v79
    ds_write_b128 v7, v[148:151] offset:5120
    s_waitcnt vmcnt(16)
    v_cvt_pk_bf16_f32 v152, v80, v81
    v_cvt_pk_bf16_f32 v153, v82, v83
    s_waitcnt vmcnt(15)
    v_cvt_pk_bf16_f32 v154, v84, v85
    v_cvt_pk_bf16_f32 v155, v86, v87
    ds_write_b128 v7, v[152:155] offset:6144
    s_waitcnt vmcnt(14)
    v_cvt_pk_bf16_f32 v156, v88, v89
    v_cvt_pk_bf16_f32 v157, v90, v91
    s_waitcnt vmcnt(13)
    v_cvt_pk_bf16_f32 v158, v92, v93
    v_cvt_pk_bf16_f32 v159, v94, v95
    ds_write_b128 v7, v[156:159] offset:7168
    v_mov_b32 v160, 0
    v_mov_b32 v161, 0
    v_mov_b32 v162, 0
    v_mov_b32 v163, 0
    v_mov_b32 v164, 0
    v_mov_b32 v165, 0
    v_mov_b32 v166, 0
    v_mov_b32 v167, 0
    v_mov_b32 v168, 0
    v_mov_b32 v169, 0
    v_mov_b32 v170, 0
    v_mov_b32 v171, 0
    v_mov_b32 v172, 0
    v_mov_b32 v173, 0
    v_mov_b32 v174, 0
    v_mov_b32 v175, 0
    v_mov_b32 v176, 0
    v_mov_b32 v177, 0
    v_mov_b32 v178, 0
    v_mov_b32 v179, 0
    v_mov_b32 v180, 0
    v_mov_b32 v181, 0
    v_mov_b32 v182, 0
    v_mov_b32 v183, 0
    v_mov_b32 v184, 0
    v_mov_b32 v185, 0
    v_mov_b32 v186, 0
    v_mov_b32 v187, 0
    v_mov_b32 v188, 0
    v_mov_b32 v189, 0
    v_mov_b32 v190, 0
    v_mov_b32 v191, 0
    s_lshl_b32 s42, s40, 14
    v_add_u32 v12, s42, v4
    s_lshl_b32 s42, s40, 13
    v_add_u32 v13, s42, v5
    s_waitcnt vmcnt(5)
    s_waitcnt lgkmcnt(0)
    s_barrier
    s_add_u32 s42, s47, 4096
    buffer_load_dwordx4 v[112:115], v4, s[8:11], s42 offen
    buffer_load_dwordx4 v[116:119], v4, s[8:11], s42 offen offset:1024
    s_add_u32 s42, s47, 6144
    buffer_load_dwordx4 v[120:123], v4, s[8:11], s42 offen
    buffer_load_dwordx4 v[124:127], v4, s[8:11], s42 offen offset:1024
    s_mov_b32 s52, s50
    s_mov_b32 s53, s51
    s_mov_b32 s54, 1835008
    s_mov_b32 s55, 131072
    s_and_b32 s49, s2, 4294967288
    s_add_u32 s49, s49, s36
    s_add_u32 s42, s49, 0
    s_lshl_b32 s42, s42, 10
    buffer_load_dwordx4 v[232:235], v4, s[52:55], s42 offen
    s_add_u32 s42, s49, 256
    s_lshl_b32 s42, s42, 10
    buffer_load_dwordx4 v[236:239], v4, s[52:55], s42 offen
    s_add_u32 s42, s49, 512
    s_lshl_b32 s42, s42, 10
    buffer_load_dwordx4 v[240:243], v4, s[52:55], s42 offen
    s_add_u32 s42, s49, 768
    s_lshl_b32 s42, s42, 10
    buffer_load_dwordx4 v[244:247], v4, s[52:55], s42 offen
    s_add_u32 s42, s49, 1024
    s_lshl_b32 s42, s42, 10
    buffer_load_dwordx4 v[248:251], v4, s[52:55], s42 offen
    s_add_u32 s42, s49, 1280
    s_lshl_b32 s42, s42, 10
    buffer_load_dwordx4 v[252:255], v4, s[52:55], s42 offen
    s_add_u32 s42, s49, 1536
    s_lshl_b32 s42, s42, 10
    buffer_load_dwordx4 v[28:31], v4, s[52:55], s42 offen
    ds_read_b128 v[32:35], v12
    ds_read_b128 v[36:39], v12 offset:1024
    ds_read_b128 v[40:43], v12 offset:2048
    ds_read_b128 v[44:47], v12 offset:3072
    ds_read_b64_tr_b16 v[56:57], v13
    ds_read_b64_tr_b16 v[58:59], v13 offset:512
    ds_read_b64_tr_b16 v[60:61], v13 offset:32768
    ds_read_b64_tr_b16 v[62:63], v13 offset:33280
    s_waitcnt vmcnt(15) lgkmcnt(7)
    v_mfma_f32_32x32x16_bf16 v[192:207], v[32:35], v[96:99], 0
    s_waitcnt vmcnt(14) lgkmcnt(6)
    v_mfma_f32_32x32x16_bf16 v[192:207], v[36:39], v[100:103], v[192:207]
    ds_read_b128 v[48:51], v12 offset:4096
    ds_read_b128 v[52:55], v12 offset:5120
    s_waitcnt vmcnt(13) lgkmcnt(7)
    v_mfma_f32_32x32x16_bf16 v[208:223], v[40:43], v[104:107], 0
    s_waitcnt vmcnt(12) lgkmcnt(6)
    v_mfma_f32_32x32x16_bf16 v[208:223], v[44:47], v[108:111], v[208:223]
    s_nop 5
    v_mov_b32 v10, v200
    v_mov_b32 v11, v200
    s_nop 1
    v_permlane32_swap_b32 v10, v11
    v_add_f32 v10, 897988541, v10
    v_rcp_f32 v10, v10
    s_nop 0
    v_mul_f32 v192, v192, v10
    v_mul_f32 v193, v193, v10
    v_mul_f32 v194, v194, v10
    v_mul_f32 v195, v195, v10
    v_mul_f32 v196, v196, v10
    v_mul_f32 v197, v197, v10
    v_mul_f32 v198, v198, v10
    v_mul_f32 v199, v199, v10
    v_cvt_pk_bf16_f32 v224, v192, v193
    v_cvt_pk_bf16_f32 v225, v194, v195
    v_cvt_pk_bf16_f32 v226, v196, v197
    v_cvt_pk_bf16_f32 v227, v198, v199
    s_waitcnt lgkmcnt(4)
    s_nop 0
    v_mfma_f32_32x32x16_bf16 v[160:175], v[56:59], v[224:227], v[160:175]
    ds_read_b64_tr_b16 v[64:65], v13 offset:1024
    ds_read_b64_tr_b16 v[66:67], v13 offset:1536
    ds_read_b64_tr_b16 v[68:69], v13 offset:33792
    ds_read_b64_tr_b16 v[70:71], v13 offset:34304
    ds_read_b128 v[32:35], v12 offset:6144
    ds_read_b128 v[36:39], v12 offset:7168
    s_waitcnt lgkmcnt(8)
    v_mfma_f32_32x32x16_bf16 v[176:191], v[60:63], v[224:227], v[176:191]
    s_add_u32 s42, s47, 8192
    buffer_load_dwordx4 v[96:99], v4, s[8:11], s42 offen
    buffer_load_dwordx4 v[100:103], v4, s[8:11], s42 offen offset:1024
    v_mov_b32 v10, v216
    v_mov_b32 v11, v216
    s_nop 1
    v_permlane32_swap_b32 v10, v11
    v_add_f32 v10, 897988541, v10
    v_rcp_f32 v10, v10
    s_waitcnt vmcnt(12) lgkmcnt(7)
    v_mfma_f32_32x32x16_bf16 v[192:207], v[48:51], v[112:115], 0
    v_mul_f32 v208, v208, v10
    v_mul_f32 v209, v209, v10
    v_mul_f32 v210, v210, v10
    v_mul_f32 v211, v211, v10
    v_mul_f32 v212, v212, v10
    v_mul_f32 v213, v213, v10
    s_waitcnt vmcnt(11) lgkmcnt(6)
    v_mfma_f32_32x32x16_bf16 v[192:207], v[52:55], v[116:119], v[192:207]
    v_mul_f32 v214, v214, v10
    v_mul_f32 v215, v215, v10
    v_cvt_pk_bf16_f32 v228, v208, v209
    v_cvt_pk_bf16_f32 v229, v210, v211
    v_cvt_pk_bf16_f32 v230, v212, v213
    v_cvt_pk_bf16_f32 v231, v214, v215
    s_waitcnt lgkmcnt(4)
    s_nop 0
    v_mfma_f32_32x32x16_bf16 v[160:175], v[64:67], v[228:231], v[160:175]
    ds_read_b64_tr_b16 v[56:57], v13 offset:2048
    ds_read_b64_tr_b16 v[58:59], v13 offset:2560
    ds_read_b64_tr_b16 v[60:61], v13 offset:34816
    ds_read_b64_tr_b16 v[62:63], v13 offset:35328
    ds_read_b128 v[40:43], v12 offset:8192
    ds_read_b128 v[44:47], v12 offset:9216
    s_waitcnt lgkmcnt(8)
    v_mfma_f32_32x32x16_bf16 v[176:191], v[68:71], v[228:231], v[176:191]
    s_add_u32 s42, s47, 10240
    buffer_load_dwordx4 v[104:107], v4, s[8:11], s42 offen
    buffer_load_dwordx4 v[108:111], v4, s[8:11], s42 offen offset:1024
    v_mov_b32 v10, v200
    v_mov_b32 v11, v200
    s_nop 1
    v_permlane32_swap_b32 v10, v11
    v_add_f32 v10, 897988541, v10
    v_rcp_f32 v10, v10
    s_waitcnt vmcnt(12) lgkmcnt(7)
    v_mfma_f32_32x32x16_bf16 v[208:223], v[32:35], v[120:123], 0
    v_mul_f32 v192, v192, v10
    v_mul_f32 v193, v193, v10
    v_mul_f32 v194, v194, v10
    v_mul_f32 v195, v195, v10
    v_mul_f32 v196, v196, v10
    v_mul_f32 v197, v197, v10
    s_waitcnt vmcnt(11) lgkmcnt(6)
    v_mfma_f32_32x32x16_bf16 v[208:223], v[36:39], v[124:127], v[208:223]
    v_mul_f32 v198, v198, v10
    v_mul_f32 v199, v199, v10
    v_cvt_pk_bf16_f32 v224, v192, v193
    v_cvt_pk_bf16_f32 v225, v194, v195
    v_cvt_pk_bf16_f32 v226, v196, v197
    v_cvt_pk_bf16_f32 v227, v198, v199
    s_waitcnt lgkmcnt(4)
    s_nop 0
    v_mfma_f32_32x32x16_bf16 v[160:175], v[56:59], v[224:227], v[160:175]
    ds_read_b64_tr_b16 v[64:65], v13 offset:3072
    ds_read_b64_tr_b16 v[66:67], v13 offset:3584
    ds_read_b64_tr_b16 v[68:69], v13 offset:35840
    ds_read_b64_tr_b16 v[70:71], v13 offset:36352
    ds_read_b128 v[48:51], v12 offset:10240
    ds_read_b128 v[52:55], v12 offset:11264
    s_waitcnt lgkmcnt(8)
    v_mfma_f32_32x32x16_bf16 v[176:191], v[60:63], v[224:227], v[176:191]
    s_add_u32 s42, s47, 12288
    buffer_load_dwordx4 v[112:115], v4, s[8:11], s42 offen
    buffer_load_dwordx4 v[116:119], v4, s[8:11], s42 offen offset:1024
    v_mov_b32 v10, v216
    v_mov_b32 v11, v216
    s_nop 1
    v_permlane32_swap_b32 v10, v11
    v_add_f32 v10, 897988541, v10
    v_rcp_f32 v10, v10
    s_waitcnt vmcnt(5) lgkmcnt(7)
    v_mfma_f32_32x32x16_bf16 v[192:207], v[40:43], v[96:99], 0
    v_mul_f32 v208, v208, v10
    v_mul_f32 v209, v209, v10
    v_mul_f32 v210, v210, v10
    v_mul_f32 v211, v211, v10
    v_mul_f32 v212, v212, v10
    v_mul_f32 v213, v213, v10
    s_waitcnt vmcnt(4) lgkmcnt(6)
    v_mfma_f32_32x32x16_bf16 v[192:207], v[44:47], v[100:103], v[192:207]
    v_mul_f32 v214, v214, v10
    v_mul_f32 v215, v215, v10
    v_cvt_pk_bf16_f32 v228, v208, v209
    v_cvt_pk_bf16_f32 v229, v210, v211
    v_cvt_pk_bf16_f32 v230, v212, v213
    v_cvt_pk_bf16_f32 v231, v214, v215
    s_waitcnt lgkmcnt(4)
    s_nop 0
    v_mfma_f32_32x32x16_bf16 v[160:175], v[64:67], v[228:231], v[160:175]
    ds_read_b64_tr_b16 v[56:57], v13 offset:4096
    ds_read_b64_tr_b16 v[58:59], v13 offset:4608
    ds_read_b64_tr_b16 v[60:61], v13 offset:36864
    ds_read_b64_tr_b16 v[62:63], v13 offset:37376
    ds_read_b128 v[32:35], v12 offset:12288
    ds_read_b128 v[36:39], v12 offset:13312
    s_waitcnt lgkmcnt(8)
    v_mfma_f32_32x32x16_bf16 v[176:191], v[68:71], v[228:231], v[176:191]
    s_add_u32 s42, s47, 14336
    buffer_load_dwordx4 v[120:123], v4, s[8:11], s42 offen
    buffer_load_dwordx4 v[124:127], v4, s[8:11], s42 offen offset:1024
    v_mov_b32 v10, v200
    v_mov_b32 v11, v200
    s_nop 1
    v_permlane32_swap_b32 v10, v11
    v_add_f32 v10, 897988541, v10
    v_rcp_f32 v10, v10
    s_waitcnt vmcnt(5) lgkmcnt(7)
    v_mfma_f32_32x32x16_bf16 v[208:223], v[48:51], v[104:107], 0
    v_mul_f32 v192, v192, v10
    v_mul_f32 v193, v193, v10
    v_mul_f32 v194, v194, v10
    v_mul_f32 v195, v195, v10
    v_mul_f32 v196, v196, v10
    v_mul_f32 v197, v197, v10
    s_waitcnt vmcnt(4) lgkmcnt(6)
    v_mfma_f32_32x32x16_bf16 v[208:223], v[52:55], v[108:111], v[208:223]
    v_mul_f32 v198, v198, v10
    v_mul_f32 v199, v199, v10
    v_cvt_pk_bf16_f32 v224, v192, v193
    v_cvt_pk_bf16_f32 v225, v194, v195
    v_cvt_pk_bf16_f32 v226, v196, v197
    v_cvt_pk_bf16_f32 v227, v198, v199
    s_waitcnt lgkmcnt(4)
    s_nop 0
    v_mfma_f32_32x32x16_bf16 v[160:175], v[56:59], v[224:227], v[160:175]
    ds_read_b64_tr_b16 v[64:65], v13 offset:5120
    ds_read_b64_tr_b16 v[66:67], v13 offset:5632
    ds_read_b64_tr_b16 v[68:69], v13 offset:37888
    ds_read_b64_tr_b16 v[70:71], v13 offset:38400
    ds_read_b128 v[40:43], v12 offset:14336
    ds_read_b128 v[44:47], v12 offset:15360
    s_waitcnt lgkmcnt(8)
    v_mfma_f32_32x32x16_bf16 v[176:191], v[60:63], v[224:227], v[176:191]
    v_mov_b32 v10, v216
    v_mov_b32 v11, v216
    s_nop 1
    v_permlane32_swap_b32 v10, v11
    v_add_f32 v10, 897988541, v10
    v_rcp_f32 v10, v10
    s_nop 0
    v_mul_f32 v208, v208, v10
    s_waitcnt vmcnt(3) lgkmcnt(7)
    v_mfma_f32_32x32x16_bf16 v[192:207], v[32:35], v[112:115], 0
    v_mul_f32 v209, v209, v10
    v_mul_f32 v210, v210, v10
    v_mul_f32 v211, v211, v10
    v_mul_f32 v212, v212, v10
    v_mul_f32 v213, v213, v10
    v_mul_f32 v214, v214, v10
    s_waitcnt vmcnt(2) lgkmcnt(6)
    v_mfma_f32_32x32x16_bf16 v[192:207], v[36:39], v[116:119], v[192:207]
    v_mul_f32 v215, v215, v10
    v_cvt_pk_bf16_f32 v228, v208, v209
    v_cvt_pk_bf16_f32 v229, v210, v211
    v_cvt_pk_bf16_f32 v230, v212, v213
    v_cvt_pk_bf16_f32 v231, v214, v215
    s_waitcnt lgkmcnt(4)
    s_nop 0
    v_mfma_f32_32x32x16_bf16 v[160:175], v[64:67], v[228:231], v[160:175]
    ds_read_b64_tr_b16 v[56:57], v13 offset:6144
    ds_read_b64_tr_b16 v[58:59], v13 offset:6656
    ds_read_b64_tr_b16 v[60:61], v13 offset:38912
    ds_read_b64_tr_b16 v[62:63], v13 offset:39424
    v_mov_b32 v10, v200
    v_mov_b32 v11, v200
    s_waitcnt lgkmcnt(6)
    v_mfma_f32_32x32x16_bf16 v[176:191], v[68:71], v[228:231], v[176:191]
    v_permlane32_swap_b32 v10, v11
    v_add_f32 v10, 897988541, v10
    v_rcp_f32 v10, v10
    s_nop 0
    v_mul_f32 v192, v192, v10
    v_mul_f32 v193, v193, v10
    s_waitcnt vmcnt(1) lgkmcnt(5)
    v_mfma_f32_32x32x16_bf16 v[208:223], v[40:43], v[120:123], 0
    v_mul_f32 v194, v194, v10
    v_mul_f32 v195, v195, v10
    v_mul_f32 v196, v196, v10
    v_mul_f32 v197, v197, v10
    v_mul_f32 v198, v198, v10
    s_waitcnt vmcnt(0) lgkmcnt(4)
    v_mfma_f32_32x32x16_bf16 v[208:223], v[44:47], v[124:127], v[208:223]
    v_mul_f32 v199, v199, v10
    v_cvt_pk_bf16_f32 v224, v192, v193
    v_cvt_pk_bf16_f32 v225, v194, v195
    v_cvt_pk_bf16_f32 v226, v196, v197
    v_cvt_pk_bf16_f32 v227, v198, v199
    s_waitcnt lgkmcnt(2)
    s_nop 0
    v_mfma_f32_32x32x16_bf16 v[160:175], v[56:59], v[224:227], v[160:175]
    ds_read_b64_tr_b16 v[64:65], v13 offset:7168
    ds_read_b64_tr_b16 v[66:67], v13 offset:7680
    ds_read_b64_tr_b16 v[68:69], v13 offset:39936
    ds_read_b64_tr_b16 v[70:71], v13 offset:40448
    v_mov_b32 v10, v216
    v_mov_b32 v11, v216
    s_nop 1
    v_permlane32_swap_b32 v10, v11
    v_add_f32 v10, 897988541, v10
    v_rcp_f32 v10, v10
    s_nop 0
    v_mul_f32 v208, v208, v10
    v_mul_f32 v209, v209, v10
    s_waitcnt lgkmcnt(4)
    v_mfma_f32_32x32x16_bf16 v[176:191], v[60:63], v[224:227], v[176:191]
    v_mul_f32 v210, v210, v10
    v_mul_f32 v211, v211, v10
    v_mul_f32 v212, v212, v10
    v_mul_f32 v213, v213, v10
    v_mul_f32 v214, v214, v10
    v_mul_f32 v215, v215, v10
    v_cvt_pk_bf16_f32 v228, v208, v209
    v_cvt_pk_bf16_f32 v229, v210, v211
    v_cvt_pk_bf16_f32 v230, v212, v213
    v_cvt_pk_bf16_f32 v231, v214, v215
    s_waitcnt lgkmcnt(2)
    s_nop 0
    v_mfma_f32_32x32x16_bf16 v[160:175], v[64:67], v[228:231], v[160:175]
    s_waitcnt lgkmcnt(0)
    v_mfma_f32_32x32x16_bf16 v[176:191], v[68:71], v[228:231], v[176:191]
    s_barrier
    v_lshl_add_u32 v14, v2, 13, v4
    s_nop 7
    ds_write_b128 v14, v[160:163]
    ds_write_b128 v14, v[164:167] offset:1024
    ds_write_b128 v14, v[168:171] offset:2048
    ds_write_b128 v14, v[172:175] offset:3072
    ds_write_b128 v14, v[176:179] offset:4096
    ds_write_b128 v14, v[180:183] offset:5120
    ds_write_b128 v14, v[184:187] offset:6144
    ds_write_b128 v14, v[188:191] offset:7168
    s_waitcnt lgkmcnt(0)
    s_barrier
    s_lshl_b32 s42, s40, 11
    v_add_u32 v15, s42, v4
    s_lshl_b32 s42, s39, 13
    v_add_u32 v15, s42, v15
    ds_read_b128 v[72:75], v15
    ds_read_b128 v[76:79], v15 offset:1024
    ds_read_b128 v[80:83], v15 offset:16384
    ds_read_b128 v[84:87], v15 offset:17408
    ds_read_b128 v[88:91], v15 offset:32768
    ds_read_b128 v[92:95], v15 offset:33792
    ds_read_b128 v[96:99], v15 offset:49152
    ds_read_b128 v[100:103], v15 offset:50176
    s_waitcnt lgkmcnt(5)
    v_add_f32 v64, v72, v80
    v_add_f32 v65, v73, v81
    v_add_f32 v66, v74, v82
    v_add_f32 v67, v75, v83
    s_waitcnt lgkmcnt(4)
    v_add_f32 v68, v76, v84
    v_add_f32 v69, v77, v85
    v_add_f32 v70, v78, v86
    v_add_f32 v71, v79, v87
    s_waitcnt lgkmcnt(3)
    v_add_f32 v64, v64, v88
    v_add_f32 v65, v65, v89
    v_add_f32 v66, v66, v90
    v_add_f32 v67, v67, v91
    s_waitcnt lgkmcnt(2)
    v_add_f32 v68, v68, v92
    v_add_f32 v69, v69, v93
    v_add_f32 v70, v70, v94
    v_add_f32 v71, v71, v95
    s_waitcnt lgkmcnt(1)
    v_add_f32 v64, v64, v96
    v_add_f32 v65, v65, v97
    v_add_f32 v66, v66, v98
    v_add_f32 v67, v67, v99
    s_waitcnt lgkmcnt(0)
    v_add_f32 v68, v68, v100
    v_add_f32 v69, v69, v101
    v_add_f32 v70, v70, v102
    v_add_f32 v71, v71, v103
    v_cvt_pk_bf16_f32 v104, v64, v65
    v_cvt_pk_bf16_f32 v105, v66, v67
    v_cvt_pk_bf16_f32 v106, v68, v69
    v_cvt_pk_bf16_f32 v107, v70, v71
    v_lshlrev_b32 v108, 16, v104
    v_and_b32 v109, 4294901760, v104
    v_lshlrev_b32 v116, 16, v24
    v_and_b32 v117, 4294901760, v24
    v_lshlrev_b32 v110, 16, v105
    v_and_b32 v111, 4294901760, v105
    v_lshlrev_b32 v118, 16, v25
    v_and_b32 v119, 4294901760, v25
    v_lshlrev_b32 v112, 16, v106
    v_and_b32 v113, 4294901760, v106
    v_lshlrev_b32 v120, 16, v26
    v_and_b32 v121, 4294901760, v26
    v_lshlrev_b32 v114, 16, v107
    v_and_b32 v115, 4294901760, v107
    v_lshlrev_b32 v122, 16, v27
    v_and_b32 v123, 4294901760, v27
    v_add_f32 v108, v108, v116
    v_add_f32 v109, v109, v117
    v_add_f32 v110, v110, v118
    v_add_f32 v111, v111, v119
    v_add_f32 v112, v112, v120
    v_add_f32 v113, v113, v121
    v_add_f32 v114, v114, v122
    v_add_f32 v115, v115, v123
    v_cvt_pk_bf16_f32 v124, v108, v109
    v_cvt_pk_bf16_f32 v125, v110, v111
    v_cvt_pk_bf16_f32 v126, v112, v113
    v_cvt_pk_bf16_f32 v127, v114, v115
    buffer_store_dwordx4 v[124:127], v4, s[24:27], s48 offen
    v_lshlrev_b32 v108, 16, v124
    v_and_b32 v109, 4294901760, v124
    v_lshlrev_b32 v110, 16, v125
    v_and_b32 v111, 4294901760, v125
    v_lshlrev_b32 v112, 16, v126
    v_and_b32 v113, 4294901760, v126
    v_lshlrev_b32 v114, 16, v127
    v_and_b32 v115, 4294901760, v127
    v_add_f32 v128, v108, v109
    v_add_f32 v128, v128, v110
    v_add_f32 v128, v128, v111
    v_add_f32 v128, v128, v112
    v_add_f32 v128, v128, v113
    v_add_f32 v128, v128, v114
    v_add_f32 v128, v128, v115
    v_mov_b32 v129, v128
    s_nop 1
    v_permlane32_swap_b32 v128, v129
    v_add_f32 v128, v128, v129
    v_mul_f32 v128, 1031798784, v128
    v_sub_f32 v108, v108, v128
    v_sub_f32 v109, v109, v128
    v_sub_f32 v110, v110, v128
    v_sub_f32 v111, v111, v128
    v_sub_f32 v112, v112, v128
    v_sub_f32 v113, v113, v128
    v_sub_f32 v114, v114, v128
    v_sub_f32 v115, v115, v128
    v_mul_f32 v130, v108, v108
    v_fmac_f32 v130, v109, v109
    v_fmac_f32 v130, v110, v110
    v_fmac_f32 v130, v111, v111
    v_fmac_f32 v130, v112, v112
    v_fmac_f32 v130, v113, v113
    v_fmac_f32 v130, v114, v114
    v_fmac_f32 v130, v115, v115
    v_mov_b32 v129, v130
    s_nop 1
    v_permlane32_swap_b32 v130, v129
    v_add_f32 v130, v130, v129
    v_mov_b32 v132, v128
    v_mov_b32 v133, v130
    v_and_b32 v131, 31, v1
    v_lshlrev_b32 v131, 3, v131
    v_lshl_add_u32 v131, v2, 8, v131
    v_add_u32 v131, 65536, v131
    ds_write_b64 v131, v[132:133]
    s_waitcnt lgkmcnt(0)
    s_barrier
    s_nop 15
    s_cmp_lg_u32 s40, 0
    s_cbranch_scc1 k2_attn_kernel_end
    v_and_b32 v131, 31, v1
    v_lshlrev_b32 v131, 3, v131
    s_lshl_b32 s42, s39, 8
    v_add_u32 v131, s42, v131
    v_add_u32 v131, 65536, v131
    ds_read_b64 v[136:137], v131
    ds_read_b64 v[138:139], v131 offset:512
    ds_read_b64 v[140:141], v131 offset:1024
    ds_read_b64 v[142:143], v131 offset:1536
    s_waitcnt lgkmcnt(2)
    v_add_f32 v128, v136, v138
    s_waitcnt lgkmcnt(1)
    v_add_f32 v128, v128, v140
    s_waitcnt lgkmcnt(0)
    v_add_f32 v128, v128, v142
    v_mul_f32 v128, 1048576000, v128
    v_add_f32 v130, v137, v139
    v_add_f32 v130, v130, v141
    v_add_f32 v130, v130, v143
    v_sub_f32 v136, v136, v128
    v_sub_f32 v138, v138, v128
    v_sub_f32 v140, v140, v128
    v_sub_f32 v142, v142, v128
    v_mul_f32 v129, v136, v136
    v_fmac_f32 v129, v138, v138
    v_fmac_f32 v129, v140, v140
    v_fmac_f32 v129, v142, v142
    v_mul_f32 v129, 1098907648, v129
    v_add_f32 v130, v130, v129
    v_mov_b32 v132, v128
    v_mov_b32 v133, v130
    v_and_b32 v144, 31, v1
    v_lshlrev_b32 v144, 6, v144
    s_lshl_b32 s42, s41, 11
    s_lshl_b32 s43, s37, 3
    s_add_u32 s42, s42, s43
    buffer_store_dwordx2 v[132:133], v144, s[28:31], s42 offen
k2_attn_kernel_end:
    s_endpgm
.globl k3_ffn1_kernel
.p2align 8
.type k3_ffn1_kernel,@function
k3_ffn1_kernel:
    s_cmp_ge_u32 s2, 256
    s_cbranch_scc1 k3_ffn1_kernel_end
    s_load_dwordx2 s[4:5], s[0:1], 80
    s_load_dwordx2 s[6:7], s[0:1], 40
    s_load_dwordx2 s[8:9], s[0:1], 48
    v_and_b32 v1, 63, v0
    v_lshrrev_b32 v2, 6, v0
    s_nop 0
    v_readfirstlane_b32 s32, v2
    s_and_b32 s35, s2, 7
    s_lshr_b32 s33, s35, 2
    s_and_b32 s34, s35, 3
    s_lshr_b32 s35, s2, 3
    s_lshr_b32 s36, s35, 2
    s_lshl_b32 s36, s36, 1
    s_add_u32 s33, s33, s36
    s_lshl_b32 s34, s34, 2
    s_and_b32 s36, s35, 3
    s_add_u32 s34, s34, s36
    s_and_b32 s43, s32, 3
    s_lshr_b32 s44, s32, 2
    v_lshlrev_b32 v3, 4, v1
    v_lshrrev_b32 v8, 5, v1
    v_lshlrev_b32 v8, 2, v8
    v_bfe_u32 v9, v1, 2, 2
    v_add_u32 v8, v8, v9
    v_mul_u32_u24 v4, 224, v8
    v_bfe_u32 v8, v1, 4, 1
    v_mul_u32_u24 v8, 14464, v8
    v_add_u32 v4, v4, v8
    v_and_b32 v9, 3, v1
    v_lshl_add_u32 v4, v9, 3, v4
    v_add_u32 v10, 0, v2
    v_subrev_u32 v8, 14, v10
    v_cmp_gt_u32 vcc, 14, v10
    s_nop 1
    v_cndmask_b32 v8, v8, v10, vcc
    v_lshl_add_u32 v8, v8, 6, v1
    v_mul_u32_u24 v9, 4682, v8
    v_lshrrev_b32 v9, 16, v9
    v_mul_u32_u24 v16, 14, v9
    v_sub_u32 v16, v8, v16
    v_lshlrev_b32 v16, 4, v16
    v_mul_u32_u24 v9, 3584, v9
    v_add_u32 v16, v16, v9
    v_add_u32 v10, 8, v2
    v_subrev_u32 v8, 14, v10
    v_cmp_gt_u32 vcc, 14, v10
    s_nop 1
    v_cndmask_b32 v8, v8, v10, vcc
    v_lshl_add_u32 v8, v8, 6, v1
    v_mul_u32_u24 v9, 4682, v8
    v_lshrrev_b32 v9, 16, v9
    v_mul_u32_u24 v17, 14, v9
    v_sub_u32 v17, v8, v17
    v_lshlrev_b32 v17, 4, v17
    v_mul_u32_u24 v9, 3584, v9
    v_add_u32 v17, v17, v9
    v_add_u32 v10, 16, v2
    v_subrev_u32 v8, 14, v10
    v_cmp_gt_u32 vcc, 14, v10
    s_nop 1
    v_cndmask_b32 v8, v8, v10, vcc
    v_lshl_add_u32 v8, v8, 6, v1
    v_mul_u32_u24 v9, 4682, v8
    v_lshrrev_b32 v9, 16, v9
    v_mul_u32_u24 v18, 14, v9
    v_sub_u32 v18, v8, v18
    v_lshlrev_b32 v18, 4, v18
    v_mul_u32_u24 v9, 3584, v9
    v_add_u32 v18, v18, v9
    v_add_u32 v10, 24, v2
    v_cmp_gt_u32 vcc, 28, v10
    s_nop 1
    v_cndmask_b32 v10, v2, v10, vcc
    v_subrev_u32 v8, 14, v10
    v_cmp_gt_u32 vcc, 14, v10
    s_nop 1
    v_cndmask_b32 v8, v8, v10, vcc
    v_lshl_add_u32 v8, v8, 6, v1
    v_mul_u32_u24 v9, 4682, v8
    v_lshrrev_b32 v9, 16, v9
    v_mul_u32_u24 v19, 14, v9
    v_sub_u32 v19, v8, v19
    v_lshlrev_b32 v19, 4, v19
    v_mul_u32_u24 v9, 3584, v9
    v_add_u32 v19, v19, v9
    s_waitcnt lgkmcnt(0)
    s_mov_b32 s24, s6
    s_mov_b32 s25, s7
    s_mov_b32 s26, 1835008
    s_mov_b32 s27, 131072
    s_mov_b32 s28, s8
    s_mov_b32 s29, s9
    s_mov_b32 s30, 1835008
    s_mov_b32 s31, 131072
    s_mul_i32 s38, s34, 224
    s_add_u32 s35, s32, 0
    s_cmp_ge_u32 s35, 14
    s_cselect_b32 s46, 1, 0
    s_cselect_b32 s36, 14, 0
    s_sub_u32 s35, s35, s36
    s_lshl_b32 s45, s35, 10
    s_mul_i32 s36, s46, 14464
    s_add_u32 s45, s45, s36
    s_add_u32 s35, s32, 8
    s_cmp_ge_u32 s35, 14
    s_cselect_b32 s48, 1, 0
    s_cselect_b32 s36, 14, 0
    s_sub_u32 s35, s35, s36
    s_lshl_b32 s47, s35, 10
    s_mul_i32 s36, s48, 14464
    s_add_u32 s47, s47, s36
    s_add_u32 s35, s32, 16
    s_cmp_ge_u32 s35, 14
    s_cselect_b32 s50, 1, 0
    s_cselect_b32 s36, 14, 0
    s_sub_u32 s35, s35, s36
    s_lshl_b32 s49, s35, 10
    s_mul_i32 s36, s50, 14464
    s_add_u32 s49, s49, s36
    s_add_u32 s35, s32, 24
    s_cmp_ge_u32 s35, 28
    s_cselect_b32 s35, s32, s35
    s_cmp_ge_u32 s35, 14
    s_cselect_b32 s52, 1, 0
    s_cselect_b32 s36, 14, 0
    s_sub_u32 s35, s35, s36
    s_lshl_b32 s51, s35, 10
    s_mul_i32 s36, s52, 14464
    s_add_u32 s51, s51, s36
    s_cmp_eq_u32 s46, 0
    s_cselect_b32 s56, s24, s28
    s_cselect_b32 s57, s25, s29
    s_mov_b32 s58, 1835008
    s_mov_b32 s59, 131072
    s_cmp_eq_u32 s48, 0
    s_cselect_b32 s60, s24, s28
    s_cselect_b32 s61, s25, s29
    s_mov_b32 s62, 1835008
    s_mov_b32 s63, 131072
    s_cmp_eq_u32 s50, 0
    s_cselect_b32 s64, s24, s28
    s_cselect_b32 s65, s25, s29
    s_mov_b32 s66, 1835008
    s_mov_b32 s67, 131072
    s_cmp_eq_u32 s52, 0
    s_cselect_b32 s68, s24, s28
    s_cselect_b32 s69, s25, s29
    s_mov_b32 s70, 1835008
    s_mov_b32 s71, 131072
    s_add_u32 s16, s4, 14680064
    s_addc_u32 s17, s5, 0
    s_mov_b32 s18, 131072
    s_mov_b32 s19, 131072
    s_add_u32 s12, s4, 12582912
    s_addc_u32 s13, s5, 0
    s_mov_b32 s14, 2097152
    s_mov_b32 s15, 131072
    s_lshl_b32 s37, s33, 2
    s_add_u32 s37, s37, s43
    v_and_b32 v5, 31, v1
    v_lshlrev_b32 v5, 6, v5
    s_lshl_b32 s35, s37, 11
    buffer_load_dwordx4 v[20:23], v5, s[16:19], s35 offen
    buffer_load_dwordx4 v[24:27], v5, s[16:19], s35 offen offset:16
    buffer_load_dwordx4 v[28:31], v5, s[16:19], s35 offen offset:32
    buffer_load_dwordx4 v[32:35], v5, s[16:19], s35 offen offset:48
    s_lshl_b32 s40, s37, 15
    s_lshl_b32 s35, s44, 11
    s_add_u32 s40, s40, s35
    s_add_u32 s35, s40, 0
    buffer_load_dwordx4 v[36:39], v3, s[12:15], s35 offen
    s_add_u32 s35, s40, 1024
    buffer_load_dwordx4 v[40:43], v3, s[12:15], s35 offen
    s_add_u32 s35, s40, 4096
    buffer_load_dwordx4 v[44:47], v3, s[12:15], s35 offen
    s_add_u32 s36, s45, 0
    s_mov_b32 m0, s36
    s_add_u32 s35, s38, 0
    buffer_load_dwordx4 v16, s[56:59], s35 offen lds
    s_add_u32 s36, s47, 0
    s_mov_b32 m0, s36
    s_add_u32 s35, s38, 0
    buffer_load_dwordx4 v17, s[60:63], s35 offen lds
    s_add_u32 s36, s49, 0
    s_mov_b32 m0, s36
    s_add_u32 s35, s38, 0
    buffer_load_dwordx4 v18, s[64:67], s35 offen lds
    s_add_u32 s36, s51, 0
    s_mov_b32 m0, s36
    s_add_u32 s35, s38, 0
    buffer_load_dwordx4 v19, s[68:71], s35 offen lds
    s_add_u32 s36, s45, 28928
    s_mov_b32 m0, s36
    s_add_u32 s35, s38, 229376
    buffer_load_dwordx4 v16, s[56:59], s35 offen lds
    s_add_u32 s36, s47, 28928
    s_mov_b32 m0, s36
    s_add_u32 s35, s38, 229376
    buffer_load_dwordx4 v17, s[60:63], s35 offen lds
    s_add_u32 s36, s49, 28928
    s_mov_b32 m0, s36
    s_add_u32 s35, s38, 229376
    buffer_load_dwordx4 v18, s[64:67], s35 offen lds
    s_add_u32 s36, s51, 28928
    s_mov_b32 m0, s36
    s_add_u32 s35, s38, 229376
    buffer_load_dwordx4 v19, s[68:71], s35 offen lds
    s_add_u32 s36, s45, 57856
    s_mov_b32 m0, s36
    s_add_u32 s35, s38, 458752
    buffer_load_dwordx4 v16, s[56:59], s35 offen lds
    s_add_u32 s36, s47, 57856
    s_mov_b32 m0, s36
    s_add_u32 s35, s38, 458752
    buffer_load_dwordx4 v17, s[60:63], s35 offen lds
    s_add_u32 s36, s49, 57856
    s_mov_b32 m0, s36
    s_add_u32 s35, s38, 458752
    buffer_load_dwordx4 v18, s[64:67], s35 offen lds
    s_add_u32 s36, s51, 57856
    s_mov_b32 m0, s36
    s_add_u32 s35, s38, 458752
    buffer_load_dwordx4 v19, s[68:71], s35 offen lds
    s_add_u32 s20, s4, 16777216
    s_addc_u32 s21, s5, 0
    s_mov_b32 s22, 7340032
    s_mov_b32 s23, 131072
    s_waitcnt vmcnt(18)
    v_add_f32 v6, v20, v22
    s_waitcnt vmcnt(17)
    v_add_f32 v6, v6, v24
    v_add_f32 v6, v6, v26
    s_waitcnt vmcnt(16)
    v_add_f32 v6, v6, v28
    v_add_f32 v6, v6, v30
    s_waitcnt vmcnt(15)
    v_add_f32 v6, v6, v32
    v_add_f32 v6, v6, v34
    v_mul_f32 v6, 1040187392, v6
    v_add_f32 v7, v21, v23
    v_add_f32 v7, v7, v25
    v_add_f32 v7, v7, v27
    v_add_f32 v7, v7, v29
    v_add_f32 v7, v7, v31
    v_add_f32 v7, v7, v33
    v_add_f32 v7, v7, v35
    v_sub_f32 v20, v20, v6
    v_sub_f32 v22, v22, v6
    v_sub_f32 v24, v24, v6
    v_sub_f32 v26, v26, v6
    v_sub_f32 v28, v28, v6
    v_sub_f32 v30, v30, v6
    v_sub_f32 v32, v32, v6
    v_sub_f32 v34, v34, v6
    v_mul_f32 v8, v20, v20
    v_fmac_f32 v8, v22, v22
    v_fmac_f32 v8, v24, v24
    v_fmac_f32 v8, v26, v26
    v_fmac_f32 v8, v28, v28
    v_fmac_f32 v8, v30, v30
    v_fmac_f32 v8, v32, v32
    v_fmac_f32 v8, v34, v34
    v_mul_f32 v8, 1115684864, v8
    v_add_f32 v7, v7, v8
    v_mul_f32 v7, 989855744, v7
    v_cvt_pk_bf16_f32 v6, v6, v6
    v_lshlrev_b32 v6, 16, v6
    v_cvt_pk_bf16_f32 v7, v7, v7
    v_lshlrev_b32 v7, 16, v7
    v_add_f32 v7, 925353388, v7
    v_cvt_pk_bf16_f32 v7, v7, v7
    v_lshlrev_b32 v7, 16, v7
    v_sqrt_f32 v7, v7
    s_nop 0
    v_cvt_pk_bf16_f32 v7, v7, v7
    v_lshlrev_b32 v7, 16, v7
    v_rcp_f32 v11, v7
    s_nop 0
    v_mul_f32 v12, v6, v11
    v_sub_f32 v12, 0, v12
    v_mov_b32 v68, 0
    v_mov_b32 v69, 0
    v_mov_b32 v70, 0
    v_mov_b32 v71, 0
    v_mov_b32 v72, 0
    v_mov_b32 v73, 0
    v_mov_b32 v74, 0
    v_mov_b32 v75, 0
    v_mov_b32 v76, 0
    v_mov_b32 v77, 0
    v_mov_b32 v78, 0
    v_mov_b32 v79, 0
    v_mov_b32 v80, 0
    v_mov_b32 v81, 0
    v_mov_b32 v82, 0
    v_mov_b32 v83, 0
    v_mov_b32 v84, 0
    v_mov_b32 v85, 0
    v_mov_b32 v86, 0
    v_mov_b32 v87, 0
    v_mov_b32 v88, 0
    v_mov_b32 v89, 0
    v_mov_b32 v90, 0
    v_mov_b32 v91, 0
    v_mov_b32 v92, 0
    v_mov_b32 v93, 0
    v_mov_b32 v94, 0
    v_mov_b32 v95, 0
    v_mov_b32 v96, 0
    v_mov_b32 v97, 0
    v_mov_b32 v98, 0
    v_mov_b32 v99, 0
    v_mov_b32 v100, 0
    v_mov_b32 v101, 0
    v_mov_b32 v102, 0
    v_mov_b32 v103, 0
    v_mov_b32 v104, 0
    v_mov_b32 v105, 0
    v_mov_b32 v106, 0
    v_mov_b32 v107, 0
    v_mov_b32 v108, 0
    v_mov_b32 v109, 0
    v_mov_b32 v110, 0
    v_mov_b32 v111, 0
    v_mov_b32 v112, 0
    v_mov_b32 v113, 0
    v_mov_b32 v114, 0
    v_mov_b32 v115, 0
    v_mov_b32 v116, 0
    v_mov_b32 v117, 0
    v_mov_b32 v118, 0
    v_mov_b32 v119, 0
    v_mov_b32 v120, 0
    v_mov_b32 v121, 0
    v_mov_b32 v122, 0
    v_mov_b32 v123, 0
    v_mov_b32 v124, 0
    v_mov_b32 v125, 0
    v_mov_b32 v126, 0
    v_mov_b32 v127, 0
    v_mov_b32 v128, 0
    v_mov_b32 v129, 0
    v_mov_b32 v130, 0
    v_mov_b32 v131, 0
    v_mov_b32 v132, 0
    v_mov_b32 v133, 0
    v_mov_b32 v134, 0
    v_mov_b32 v135, 0
    v_mov_b32 v136, 0
    v_mov_b32 v137, 0
    v_mov_b32 v138, 0
    v_mov_b32 v139, 0
    v_mov_b32 v140, 0
    v_mov_b32 v141, 0
    v_mov_b32 v142, 0
    v_mov_b32 v143, 0
    v_mov_b32 v144, 0
    v_mov_b32 v145, 0
    v_mov_b32 v146, 0
    v_mov_b32 v147, 0
    v_mov_b32 v148, 0
    v_mov_b32 v149, 0
    v_mov_b32 v150, 0
    v_mov_b32 v151, 0
    v_mov_b32 v152, 0
    v_mov_b32 v153, 0
    v_mov_b32 v154, 0
    v_mov_b32 v155, 0
    v_mov_b32 v156, 0
    v_mov_b32 v157, 0
    v_mov_b32 v158, 0
    v_mov_b32 v159, 0
    v_mov_b32 v160, 0
    v_mov_b32 v161, 0
    v_mov_b32 v162, 0
    v_mov_b32 v163, 0
    v_mov_b32 v164, 0
    v_mov_b32 v165, 0
    v_mov_b32 v166, 0
    v_mov_b32 v167, 0
    v_mov_b32 v168, 0
    v_mov_b32 v169, 0
    v_mov_b32 v170, 0
    v_mov_b32 v171, 0
    v_mov_b32 v172, 0
    v_mov_b32 v173, 0
    v_mov_b32 v174, 0
    v_mov_b32 v175, 0
    v_mov_b32 v176, 0
    v_mov_b32 v177, 0
    v_mov_b32 v178, 0
    v_mov_b32 v179, 0
    s_mul_i32 s35, s44, 7168
    v_add_u32 v15, s35, v4
    s_waitcnt vmcnt(14)
    v_lshlrev_b32 v60, 16, v36
    v_and_b32 v61, 4294901760, v36
    v_lshlrev_b32 v62, 16, v37
    v_and_b32 v63, 4294901760, v37
    v_lshlrev_b32 v64, 16, v38
    v_and_b32 v65, 4294901760, v38
    v_lshlrev_b32 v66, 16, v39
    v_and_b32 v67, 4294901760, v39
    v_fma_f32 v60, v60, v11, v12
    v_fma_f32 v61, v61, v11, v12
    v_fma_f32 v62, v62, v11, v12
    v_fma_f32 v63, v63, v11, v12
    v_fma_f32 v64, v64, v11, v12
    v_fma_f32 v65, v65, v11, v12
    v_fma_f32 v66, v66, v11, v12
    v_fma_f32 v67, v67, v11, v12
    v_cvt_pk_bf16_f32 v52, v60, v61
    v_cvt_pk_bf16_f32 v53, v62, v63
    v_cvt_pk_bf16_f32 v54, v64, v65
    v_cvt_pk_bf16_f32 v55, v66, v67
    v_add_u32 v13, 0, v15
    s_waitcnt vmcnt(8)
    s_barrier
    ds_read_b64_tr_b16 a[0:1], v13
    ds_read_b64_tr_b16 a[2:3], v13 offset:1792
    ds_read_b64_tr_b16 a[4:5], v13 offset:32
    ds_read_b64_tr_b16 a[6:7], v13 offset:1824
    ds_read_b64_tr_b16 a[8:9], v13 offset:64
    ds_read_b64_tr_b16 a[10:11], v13 offset:1856
    ds_read_b64_tr_b16 a[12:13], v13 offset:96
    ds_read_b64_tr_b16 a[14:15], v13 offset:1888
    ds_read_b64_tr_b16 a[16:17], v13 offset:128
    ds_read_b64_tr_b16 a[18:19], v13 offset:1920
    ds_read_b64_tr_b16 a[20:21], v13 offset:160
    ds_read_b64_tr_b16 a[22:23], v13 offset:1952
    ds_read_b64_tr_b16 a[24:25], v13 offset:192
    ds_read_b64_tr_b16 a[26:27], v13 offset:1984
    s_waitcnt lgkmcnt(12)
    v_mfma_f32_32x32x16_bf16 v[68:83], a[0:3], v[52:55], v[68:83]
    ds_read_b64_tr_b16 a[28:29], v13 offset:3584
    ds_read_b64_tr_b16 a[30:31], v13 offset:5376
    ds_read_b64_tr_b16 a[32:33], v13 offset:3616
    ds_read_b64_tr_b16 a[34:35], v13 offset:5408
    ds_read_b64_tr_b16 a[36:37], v13 offset:3648
    s_waitcnt lgkmcnt(15)
    v_mfma_f32_32x32x16_bf16 v[84:99], a[4:7], v[52:55], v[84:99]
    ds_read_b64_tr_b16 a[38:39], v13 offset:5440
    ds_read_b64_tr_b16 a[40:41], v13 offset:3680
    ds_read_b64_tr_b16 a[42:43], v13 offset:5472
    ds_read_b64_tr_b16 a[44:45], v13 offset:3712
    ds_read_b64_tr_b16 a[46:47], v13 offset:5504
    s_waitcnt lgkmcnt(15)
    v_mfma_f32_32x32x16_bf16 v[100:115], a[8:11], v[52:55], v[100:115]
    ds_read_b64_tr_b16 a[48:49], v13 offset:3744
    ds_read_b64_tr_b16 a[50:51], v13 offset:5536
    ds_read_b64_tr_b16 a[52:53], v13 offset:3776
    ds_read_b64_tr_b16 a[54:55], v13 offset:5568
    v_lshlrev_b32 v60, 16, v40
    v_mfma_f32_32x32x16_bf16 v[116:131], a[12:15], v[52:55], v[116:131]
    v_and_b32 v61, 4294901760, v40
    v_lshlrev_b32 v62, 16, v41
    v_and_b32 v63, 4294901760, v41
    v_lshlrev_b32 v64, 16, v42
    v_and_b32 v65, 4294901760, v42
    s_waitcnt lgkmcnt(15)
    v_mfma_f32_32x32x16_bf16 v[132:147], a[16:19], v[52:55], v[132:147]
    v_lshlrev_b32 v66, 16, v43
    v_and_b32 v67, 4294901760, v43
    v_fma_f32 v60, v60, v11, v12
    v_fma_f32 v61, v61, v11, v12
    v_fma_f32 v62, v62, v11, v12
    v_mfma_f32_32x32x16_bf16 v[148:163], a[20:23], v[52:55], v[148:163]
    v_fma_f32 v63, v63, v11, v12
    v_fma_f32 v64, v64, v11, v12
    v_fma_f32 v65, v65, v11, v12
    v_fma_f32 v66, v66, v11, v12
    v_fma_f32 v67, v67, v11, v12
    s_waitcnt lgkmcnt(14)
    v_mfma_f32_32x32x16_bf16 v[164:179], a[24:27], v[52:55], v[164:179]
    v_cvt_pk_bf16_f32 v56, v60, v61
    v_cvt_pk_bf16_f32 v57, v62, v63
    v_cvt_pk_bf16_f32 v58, v64, v65
    v_cvt_pk_bf16_f32 v59, v66, v67
    s_add_u32 s35, s40, 5120
    buffer_load_dwordx4 v[48:51], v3, s[12:15], s35 offen
    s_waitcnt lgkmcnt(12)
    v_mfma_f32_32x32x16_bf16 v[68:83], a[28:31], v[56:59], v[68:83]
    s_waitcnt vmcnt(5)
    s_barrier
    v_add_u32 v14, 28928, v15
    s_add_u32 s36, s45, 86784
    s_mov_b32 m0, s36
    s_add_u32 s35, s38, 688128
    buffer_load_dwordx4 v16, s[56:59], s35 offen lds
    s_add_u32 s36, s47, 86784
    s_mov_b32 m0, s36
    s_add_u32 s35, s38, 688128
    buffer_load_dwordx4 v17, s[60:63], s35 offen lds
    s_add_u32 s36, s49, 86784
    s_mov_b32 m0, s36
    s_add_u32 s35, s38, 688128
    buffer_load_dwordx4 v18, s[64:67], s35 offen lds
    s_add_u32 s36, s51, 86784
    s_mov_b32 m0, s36
    s_add_u32 s35, s38, 688128
    buffer_load_dwordx4 v19, s[68:71], s35 offen lds
    ds_read_b64_tr_b16 a[0:1], v14
    ds_read_b64_tr_b16 a[2:3], v14 offset:1792
    ds_read_b64_tr_b16 a[4:5], v14 offset:32
    ds_read_b64_tr_b16 a[6:7], v14 offset:1824
    s_waitcnt lgkmcnt(14)
    v_mfma_f32_32x32x16_bf16 v[84:99], a[32:35], v[56:59], v[84:99]
    ds_read_b64_tr_b16 a[8:9], v14 offset:64
    ds_read_b64_tr_b16 a[10:11], v14 offset:1856
    ds_read_b64_tr_b16 a[12:13], v14 offset:96
    ds_read_b64_tr_b16 a[14:15], v14 offset:1888
    ds_read_b64_tr_b16 a[16:17], v14 offset:128
    s_waitcnt lgkmcnt(15)
    v_mfma_f32_32x32x16_bf16 v[100:115], a[36:39], v[56:59], v[100:115]
    ds_read_b64_tr_b16 a[18:19], v14 offset:1920
    ds_read_b64_tr_b16 a[20:21], v14 offset:160
    ds_read_b64_tr_b16 a[22:23], v14 offset:1952
    ds_read_b64_tr_b16 a[24:25], v14 offset:192
    ds_read_b64_tr_b16 a[26:27], v14 offset:1984
    v_mfma_f32_32x32x16_bf16 v[116:131], a[40:43], v[56:59], v[116:131]
    v_lshlrev_b32 v60, 16, v44
    v_and_b32 v61, 4294901760, v44
    v_lshlrev_b32 v62, 16, v45
    v_and_b32 v63, 4294901760, v45
    v_lshlrev_b32 v64, 16, v46
    v_and_b32 v65, 4294901760, v46
    s_waitcnt lgkmcnt(15)
    v_mfma_f32_32x32x16_bf16 v[132:147], a[44:47], v[56:59], v[132:147]
    v_lshlrev_b32 v66, 16, v47
    v_and_b32 v67, 4294901760, v47
    v_fma_f32 v60, v60, v11, v12
    v_fma_f32 v61, v61, v11, v12
    v_fma_f32 v62, v62, v11, v12
    v_mfma_f32_32x32x16_bf16 v[148:163], a[48:51], v[56:59], v[148:163]
    v_fma_f32 v63, v63, v11, v12
    v_fma_f32 v64, v64, v11, v12
    v_fma_f32 v65, v65, v11, v12
    v_fma_f32 v66, v66, v11, v12
    v_fma_f32 v67, v67, v11, v12
    s_waitcnt lgkmcnt(14)
    v_mfma_f32_32x32x16_bf16 v[164:179], a[52:55], v[56:59], v[164:179]
    v_cvt_pk_bf16_f32 v52, v60, v61
    v_cvt_pk_bf16_f32 v53, v62, v63
    v_cvt_pk_bf16_f32 v54, v64, v65
    v_cvt_pk_bf16_f32 v55, v66, v67
    s_add_u32 s35, s40, 8192
    buffer_load_dwordx4 v[36:39], v3, s[12:15], s35 offen
    s_waitcnt lgkmcnt(12)
    v_mfma_f32_32x32x16_bf16 v[68:83], a[0:3], v[52:55], v[68:83]
    ds_read_b64_tr_b16 a[28:29], v14 offset:3584
    ds_read_b64_tr_b16 a[30:31], v14 offset:5376
    ds_read_b64_tr_b16 a[32:33], v14 offset:3616
    ds_read_b64_tr_b16 a[34:35], v14 offset:5408
    ds_read_b64_tr_b16 a[36:37], v14 offset:3648
    s_waitcnt lgkmcnt(15)
    v_mfma_f32_32x32x16_bf16 v[84:99], a[4:7], v[52:55], v[84:99]
    ds_read_b64_tr_b16 a[38:39], v14 offset:5440
    ds_read_b64_tr_b16 a[40:41], v14 offset:3680
    ds_read_b64_tr_b16 a[42:43], v14 offset:5472
    ds_read_b64_tr_b16 a[44:45], v14 offset:3712
    ds_read_b64_tr_b16 a[46:47], v14 offset:5504
    s_waitcnt lgkmcnt(15)
    v_mfma_f32_32x32x16_bf16 v[100:115], a[8:11], v[52:55], v[100:115]
    ds_read_b64_tr_b16 a[48:49], v14 offset:3744
    ds_read_b64_tr_b16 a[50:51], v14 offset:5536
    ds_read_b64_tr_b16 a[52:53], v14 offset:3776
    ds_read_b64_tr_b16 a[54:55], v14 offset:5568
    s_waitcnt vmcnt(5)
    v_lshlrev_b32 v60, 16, v48
    v_mfma_f32_32x32x16_bf16 v[116:131], a[12:15], v[52:55], v[116:131]
    v_and_b32 v61, 4294901760, v48
    v_lshlrev_b32 v62, 16, v49
    v_and_b32 v63, 4294901760, v49
    v_lshlrev_b32 v64, 16, v50
    v_and_b32 v65, 4294901760, v50
    s_waitcnt lgkmcnt(15)
    v_mfma_f32_32x32x16_bf16 v[132:147], a[16:19], v[52:55], v[132:147]
    v_lshlrev_b32 v66, 16, v51
    v_and_b32 v67, 4294901760, v51
    v_fma_f32 v60, v60, v11, v12
    v_fma_f32 v61, v61, v11, v12
    v_fma_f32 v62, v62, v11, v12
    v_mfma_f32_32x32x16_bf16 v[148:163], a[20:23], v[52:55], v[148:163]
    v_fma_f32 v63, v63, v11, v12
    v_fma_f32 v64, v64, v11, v12
    v_fma_f32 v65, v65, v11, v12
    v_fma_f32 v66, v66, v11, v12
    v_fma_f32 v67, v67, v11, v12
    s_waitcnt lgkmcnt(14)
    v_mfma_f32_32x32x16_bf16 v[164:179], a[24:27], v[52:55], v[164:179]
    v_cvt_pk_bf16_f32 v56, v60, v61
    v_cvt_pk_bf16_f32 v57, v62, v63
    v_cvt_pk_bf16_f32 v58, v64, v65
    v_cvt_pk_bf16_f32 v59, v66, v67
    s_add_u32 s35, s40, 9216
    buffer_load_dwordx4 v[40:43], v3, s[12:15], s35 offen
    s_waitcnt lgkmcnt(12)
    v_mfma_f32_32x32x16_bf16 v[68:83], a[28:31], v[56:59], v[68:83]
    s_barrier
    v_add_u32 v13, 57856, v15
    s_add_u32 s36, s45, 115712
    s_mov_b32 m0, s36
    s_add_u32 s35, s38, 917504
    buffer_load_dwordx4 v16, s[56:59], s35 offen lds
    s_add_u32 s36, s47, 115712
    s_mov_b32 m0, s36
    s_add_u32 s35, s38, 917504
    buffer_load_dwordx4 v17, s[60:63], s35 offen lds
    s_add_u32 s36, s49, 115712
    s_mov_b32 m0, s36
    s_add_u32 s35, s38, 917504
    buffer_load_dwordx4 v18, s[64:67], s35 offen lds
    s_add_u32 s36, s51, 115712
    s_mov_b32 m0, s36
    s_add_u32 s35, s38, 917504
    buffer_load_dwordx4 v19, s[68:71], s35 offen lds
    ds_read_b64_tr_b16 a[0:1], v13
    ds_read_b64_tr_b16 a[2:3], v13 offset:1792
    ds_read_b64_tr_b16 a[4:5], v13 offset:32
    ds_read_b64_tr_b16 a[6:7], v13 offset:1824
    s_waitcnt lgkmcnt(14)
    v_mfma_f32_32x32x16_bf16 v[84:99], a[32:35], v[56:59], v[84:99]
    ds_read_b64_tr_b16 a[8:9], v13 offset:64
    ds_read_b64_tr_b16 a[10:11], v13 offset:1856
    ds_read_b64_tr_b16 a[12:13], v13 offset:96
    ds_read_b64_tr_b16 a[14:15], v13 offset:1888
    ds_read_b64_tr_b16 a[16:17], v13 offset:128
    s_waitcnt lgkmcnt(15)
    v_mfma_f32_32x32x16_bf16 v[100:115], a[36:39], v[56:59], v[100:115]
    ds_read_b64_tr_b16 a[18:19], v13 offset:1920
    ds_read_b64_tr_b16 a[20:21], v13 offset:160
    ds_read_b64_tr_b16 a[22:23], v13 offset:1952
    ds_read_b64_tr_b16 a[24:25], v13 offset:192
    ds_read_b64_tr_b16 a[26:27], v13 offset:1984
    v_mfma_f32_32x32x16_bf16 v[116:131], a[40:43], v[56:59], v[116:131]
    s_waitcnt vmcnt(5)
    v_lshlrev_b32 v60, 16, v36
    v_and_b32 v61, 4294901760, v36
    v_lshlrev_b32 v62, 16, v37
    v_and_b32 v63, 4294901760, v37
    v_lshlrev_b32 v64, 16, v38
    v_and_b32 v65, 4294901760, v38
    s_waitcnt lgkmcnt(15)
    v_mfma_f32_32x32x16_bf16 v[132:147], a[44:47], v[56:59], v[132:147]
    v_lshlrev_b32 v66, 16, v39
    v_and_b32 v67, 4294901760, v39
    v_fma_f32 v60, v60, v11, v12
    v_fma_f32 v61, v61, v11, v12
    v_fma_f32 v62, v62, v11, v12
    v_mfma_f32_32x32x16_bf16 v[148:163], a[48:51], v[56:59], v[148:163]
    v_fma_f32 v63, v63, v11, v12
    v_fma_f32 v64, v64, v11, v12
    v_fma_f32 v65, v65, v11, v12
    v_fma_f32 v66, v66, v11, v12
    v_fma_f32 v67, v67, v11, v12
    s_waitcnt lgkmcnt(14)
    v_mfma_f32_32x32x16_bf16 v[164:179], a[52:55], v[56:59], v[164:179]
    v_cvt_pk_bf16_f32 v52, v60, v61
    v_cvt_pk_bf16_f32 v53, v62, v63
    v_cvt_pk_bf16_f32 v54, v64, v65
    v_cvt_pk_bf16_f32 v55, v66, v67
    s_add_u32 s35, s40, 12288
    buffer_load_dwordx4 v[44:47], v3, s[12:15], s35 offen
    s_waitcnt lgkmcnt(12)
    v_mfma_f32_32x32x16_bf16 v[68:83], a[0:3], v[52:55], v[68:83]
    ds_read_b64_tr_b16 a[28:29], v13 offset:3584
    ds_read_b64_tr_b16 a[30:31], v13 offset:5376
    ds_read_b64_tr_b16 a[32:33], v13 offset:3616
    ds_read_b64_tr_b16 a[34:35], v13 offset:5408
    ds_read_b64_tr_b16 a[36:37], v13 offset:3648
    s_waitcnt lgkmcnt(15)
    v_mfma_f32_32x32x16_bf16 v[84:99], a[4:7], v[52:55], v[84:99]
    ds_read_b64_tr_b16 a[38:39], v13 offset:5440
    ds_read_b64_tr_b16 a[40:41], v13 offset:3680
    ds_read_b64_tr_b16 a[42:43], v13 offset:5472
    ds_read_b64_tr_b16 a[44:45], v13 offset:3712
    ds_read_b64_tr_b16 a[46:47], v13 offset:5504
    s_waitcnt lgkmcnt(15)
    v_mfma_f32_32x32x16_bf16 v[100:115], a[8:11], v[52:55], v[100:115]
    ds_read_b64_tr_b16 a[48:49], v13 offset:3744
    ds_read_b64_tr_b16 a[50:51], v13 offset:5536
    ds_read_b64_tr_b16 a[52:53], v13 offset:3776
    ds_read_b64_tr_b16 a[54:55], v13 offset:5568
    s_waitcnt vmcnt(5)
    v_lshlrev_b32 v60, 16, v40
    v_mfma_f32_32x32x16_bf16 v[116:131], a[12:15], v[52:55], v[116:131]
    v_and_b32 v61, 4294901760, v40
    v_lshlrev_b32 v62, 16, v41
    v_and_b32 v63, 4294901760, v41
    v_lshlrev_b32 v64, 16, v42
    v_and_b32 v65, 4294901760, v42
    s_waitcnt lgkmcnt(15)
    v_mfma_f32_32x32x16_bf16 v[132:147], a[16:19], v[52:55], v[132:147]
    v_lshlrev_b32 v66, 16, v43
    v_and_b32 v67, 4294901760, v43
    v_fma_f32 v60, v60, v11, v12
    v_fma_f32 v61, v61, v11, v12
    v_fma_f32 v62, v62, v11, v12
    v_mfma_f32_32x32x16_bf16 v[148:163], a[20:23], v[52:55], v[148:163]
    v_fma_f32 v63, v63, v11, v12
    v_fma_f32 v64, v64, v11, v12
    v_fma_f32 v65, v65, v11, v12
    v_fma_f32 v66, v66, v11, v12
    v_fma_f32 v67, v67, v11, v12
    s_waitcnt lgkmcnt(14)
    v_mfma_f32_32x32x16_bf16 v[164:179], a[24:27], v[52:55], v[164:179]
    v_cvt_pk_bf16_f32 v56, v60, v61
    v_cvt_pk_bf16_f32 v57, v62, v63
    v_cvt_pk_bf16_f32 v58, v64, v65
    v_cvt_pk_bf16_f32 v59, v66, v67
    s_add_u32 s35, s40, 13312
    buffer_load_dwordx4 v[48:51], v3, s[12:15], s35 offen
    s_waitcnt lgkmcnt(12)
    v_mfma_f32_32x32x16_bf16 v[68:83], a[28:31], v[56:59], v[68:83]
    s_barrier
    v_add_u32 v14, 86784, v15
    s_add_u32 s36, s45, 0
    s_mov_b32 m0, s36
    s_add_u32 s35, s38, 1146880
    buffer_load_dwordx4 v16, s[56:59], s35 offen lds
    s_add_u32 s36, s47, 0
    s_mov_b32 m0, s36
    s_add_u32 s35, s38, 1146880
    buffer_load_dwordx4 v17, s[60:63], s35 offen lds
    s_add_u32 s36, s49, 0
    s_mov_b32 m0, s36
    s_add_u32 s35, s38, 1146880
    buffer_load_dwordx4 v18, s[64:67], s35 offen lds
    s_add_u32 s36, s51, 0
    s_mov_b32 m0, s36
    s_add_u32 s35, s38, 1146880
    buffer_load_dwordx4 v19, s[68:71], s35 offen lds
    ds_read_b64_tr_b16 a[0:1], v14
    ds_read_b64_tr_b16 a[2:3], v14 offset:1792
    ds_read_b64_tr_b16 a[4:5], v14 offset:32
    ds_read_b64_tr_b16 a[6:7], v14 offset:1824
    s_waitcnt lgkmcnt(14)
    v_mfma_f32_32x32x16_bf16 v[84:99], a[32:35], v[56:59], v[84:99]
    ds_read_b64_tr_b16 a[8:9], v14 offset:64
    ds_read_b64_tr_b16 a[10:11], v14 offset:1856
    ds_read_b64_tr_b16 a[12:13], v14 offset:96
    ds_read_b64_tr_b16 a[14:15], v14 offset:1888
    ds_read_b64_tr_b16 a[16:17], v14 offset:128
    s_waitcnt lgkmcnt(15)
    v_mfma_f32_32x32x16_bf16 v[100:115], a[36:39], v[56:59], v[100:115]
    ds_read_b64_tr_b16 a[18:19], v14 offset:1920
    ds_read_b64_tr_b16 a[20:21], v14 offset:160
    ds_read_b64_tr_b16 a[22:23], v14 offset:1952
    ds_read_b64_tr_b16 a[24:25], v14 offset:192
    ds_read_b64_tr_b16 a[26:27], v14 offset:1984
    v_mfma_f32_32x32x16_bf16 v[116:131], a[40:43], v[56:59], v[116:131]
    s_waitcnt vmcnt(5)
    v_lshlrev_b32 v60, 16, v44
    v_and_b32 v61, 4294901760, v44
    v_lshlrev_b32 v62, 16, v45
    v_and_b32 v63, 4294901760, v45
    v_lshlrev_b32 v64, 16, v46
    v_and_b32 v65, 4294901760, v46
    s_waitcnt lgkmcnt(15)
    v_mfma_f32_32x32x16_bf16 v[132:147], a[44:47], v[56:59], v[132:147]
    v_lshlrev_b32 v66, 16, v47
    v_and_b32 v67, 4294901760, v47
    v_fma_f32 v60, v60, v11, v12
    v_fma_f32 v61, v61, v11, v12
    v_fma_f32 v62, v62, v11, v12
    v_mfma_f32_32x32x16_bf16 v[148:163], a[48:51], v[56:59], v[148:163]
    v_fma_f32 v63, v63, v11, v12
    v_fma_f32 v64, v64, v11, v12
    v_fma_f32 v65, v65, v11, v12
    v_fma_f32 v66, v66, v11, v12
    v_fma_f32 v67, v67, v11, v12
    s_waitcnt lgkmcnt(14)
    v_mfma_f32_32x32x16_bf16 v[164:179], a[52:55], v[56:59], v[164:179]
    v_cvt_pk_bf16_f32 v52, v60, v61
    v_cvt_pk_bf16_f32 v53, v62, v63
    v_cvt_pk_bf16_f32 v54, v64, v65
    v_cvt_pk_bf16_f32 v55, v66, v67
    s_add_u32 s35, s40, 16384
    buffer_load_dwordx4 v[36:39], v3, s[12:15], s35 offen
    s_waitcnt lgkmcnt(12)
    v_mfma_f32_32x32x16_bf16 v[68:83], a[0:3], v[52:55], v[68:83]
    ds_read_b64_tr_b16 a[28:29], v14 offset:3584
    ds_read_b64_tr_b16 a[30:31], v14 offset:5376
    ds_read_b64_tr_b16 a[32:33], v14 offset:3616
    ds_read_b64_tr_b16 a[34:35], v14 offset:5408
    ds_read_b64_tr_b16 a[36:37], v14 offset:3648
    s_waitcnt lgkmcnt(15)
    v_mfma_f32_32x32x16_bf16 v[84:99], a[4:7], v[52:55], v[84:99]
    ds_read_b64_tr_b16 a[38:39], v14 offset:5440
    ds_read_b64_tr_b16 a[40:41], v14 offset:3680
    ds_read_b64_tr_b16 a[42:43], v14 offset:5472
    ds_read_b64_tr_b16 a[44:45], v14 offset:3712
    ds_read_b64_tr_b16 a[46:47], v14 offset:5504
    s_waitcnt lgkmcnt(15)
    v_mfma_f32_32x32x16_bf16 v[100:115], a[8:11], v[52:55], v[100:115]
    ds_read_b64_tr_b16 a[48:49], v14 offset:3744
    ds_read_b64_tr_b16 a[50:51], v14 offset:5536
    ds_read_b64_tr_b16 a[52:53], v14 offset:3776
    ds_read_b64_tr_b16 a[54:55], v14 offset:5568
    s_waitcnt vmcnt(5)
    v_lshlrev_b32 v60, 16, v48
    v_mfma_f32_32x32x16_bf16 v[116:131], a[12:15], v[52:55], v[116:131]
    v_and_b32 v61, 4294901760, v48
    v_lshlrev_b32 v62, 16, v49
    v_and_b32 v63, 4294901760, v49
    v_lshlrev_b32 v64, 16, v50
    v_and_b32 v65, 4294901760, v50
    s_waitcnt lgkmcnt(15)
    v_mfma_f32_32x32x16_bf16 v[132:147], a[16:19], v[52:55], v[132:147]
    v_lshlrev_b32 v66, 16, v51
    v_and_b32 v67, 4294901760, v51
    v_fma_f32 v60, v60, v11, v12
    v_fma_f32 v61, v61, v11, v12
    v_fma_f32 v62, v62, v11, v12
    v_mfma_f32_32x32x16_bf16 v[148:163], a[20:23], v[52:55], v[148:163]
    v_fma_f32 v63, v63, v11, v12
    v_fma_f32 v64, v64, v11, v12
    v_fma_f32 v65, v65, v11, v12
    v_fma_f32 v66, v66, v11, v12
    v_fma_f32 v67, v67, v11, v12
    s_waitcnt lgkmcnt(14)
    v_mfma_f32_32x32x16_bf16 v[164:179], a[24:27], v[52:55], v[164:179]
    v_cvt_pk_bf16_f32 v56, v60, v61
    v_cvt_pk_bf16_f32 v57, v62, v63
    v_cvt_pk_bf16_f32 v58, v64, v65
    v_cvt_pk_bf16_f32 v59, v66, v67
    s_add_u32 s35, s40, 17408
    buffer_load_dwordx4 v[40:43], v3, s[12:15], s35 offen
    s_waitcnt lgkmcnt(12)
    v_mfma_f32_32x32x16_bf16 v[68:83], a[28:31], v[56:59], v[68:83]
    s_barrier
    v_add_u32 v13, 115712, v15
    s_add_u32 s36, s45, 28928
    s_mov_b32 m0, s36
    s_add_u32 s35, s38, 1376256
    buffer_load_dwordx4 v16, s[56:59], s35 offen lds
    s_add_u32 s36, s47, 28928
    s_mov_b32 m0, s36
    s_add_u32 s35, s38, 1376256
    buffer_load_dwordx4 v17, s[60:63], s35 offen lds
    s_add_u32 s36, s49, 28928
    s_mov_b32 m0, s36
    s_add_u32 s35, s38, 1376256
    buffer_load_dwordx4 v18, s[64:67], s35 offen lds
    s_add_u32 s36, s51, 28928
    s_mov_b32 m0, s36
    s_add_u32 s35, s38, 1376256
    buffer_load_dwordx4 v19, s[68:71], s35 offen lds
    ds_read_b64_tr_b16 a[0:1], v13
    ds_read_b64_tr_b16 a[2:3], v13 offset:1792
    ds_read_b64_tr_b16 a[4:5], v13 offset:32
    ds_read_b64_tr_b16 a[6:7], v13 offset:1824
    s_waitcnt lgkmcnt(14)
    v_mfma_f32_32x32x16_bf16 v[84:99], a[32:35], v[56:59], v[84:99]
    ds_read_b64_tr_b16 a[8:9], v13 offset:64
    ds_read_b64_tr_b16 a[10:11], v13 offset:1856
    ds_read_b64_tr_b16 a[12:13], v13 offset:96
    ds_read_b64_tr_b16 a[14:15], v13 offset:1888
    ds_read_b64_tr_b16 a[16:17], v13 offset:128
    s_waitcnt lgkmcnt(15)
    v_mfma_f32_32x32x16_bf16 v[100:115], a[36:39], v[56:59], v[100:115]
    ds_read_b64_tr_b16 a[18:19], v13 offset:1920
    ds_read_b64_tr_b16 a[20:21], v13 offset:160
    ds_read_b64_tr_b16 a[22:23], v13 offset:1952
    ds_read_b64_tr_b16 a[24:25], v13 offset:192
    ds_read_b64_tr_b16 a[26:27], v13 offset:1984
    v_mfma_f32_32x32x16_bf16 v[116:131], a[40:43], v[56:59], v[116:131]
    s_waitcnt vmcnt(5)
    v_lshlrev_b32 v60, 16, v36
    v_and_b32 v61, 4294901760, v36
    v_lshlrev_b32 v62, 16, v37
    v_and_b32 v63, 4294901760, v37
    v_lshlrev_b32 v64, 16, v38
    v_and_b32 v65, 4294901760, v38
    s_waitcnt lgkmcnt(15)
    v_mfma_f32_32x32x16_bf16 v[132:147], a[44:47], v[56:59], v[132:147]
    v_lshlrev_b32 v66, 16, v39
    v_and_b32 v67, 4294901760, v39
    v_fma_f32 v60, v60, v11, v12
    v_fma_f32 v61, v61, v11, v12
    v_fma_f32 v62, v62, v11, v12
    v_mfma_f32_32x32x16_bf16 v[148:163], a[48:51], v[56:59], v[148:163]
    v_fma_f32 v63, v63, v11, v12
    v_fma_f32 v64, v64, v11, v12
    v_fma_f32 v65, v65, v11, v12
    v_fma_f32 v66, v66, v11, v12
    v_fma_f32 v67, v67, v11, v12
    s_waitcnt lgkmcnt(14)
    v_mfma_f32_32x32x16_bf16 v[164:179], a[52:55], v[56:59], v[164:179]
    v_cvt_pk_bf16_f32 v52, v60, v61
    v_cvt_pk_bf16_f32 v53, v62, v63
    v_cvt_pk_bf16_f32 v54, v64, v65
    v_cvt_pk_bf16_f32 v55, v66, v67
    s_add_u32 s35, s40, 20480
    buffer_load_dwordx4 v[44:47], v3, s[12:15], s35 offen
    s_waitcnt lgkmcnt(12)
    v_mfma_f32_32x32x16_bf16 v[68:83], a[0:3], v[52:55], v[68:83]
    ds_read_b64_tr_b16 a[28:29], v13 offset:3584
    ds_read_b64_tr_b16 a[30:31], v13 offset:5376
    ds_read_b64_tr_b16 a[32:33], v13 offset:3616
    ds_read_b64_tr_b16 a[34:35], v13 offset:5408
    ds_read_b64_tr_b16 a[36:37], v13 offset:3648
    s_waitcnt lgkmcnt(15)
    v_mfma_f32_32x32x16_bf16 v[84:99], a[4:7], v[52:55], v[84:99]
    ds_read_b64_tr_b16 a[38:39], v13 offset:5440
    ds_read_b64_tr_b16 a[40:41], v13 offset:3680
    ds_read_b64_tr_b16 a[42:43], v13 offset:5472
    ds_read_b64_tr_b16 a[44:45], v13 offset:3712
    ds_read_b64_tr_b16 a[46:47], v13 offset:5504
    s_waitcnt lgkmcnt(15)
    v_mfma_f32_32x32x16_bf16 v[100:115], a[8:11], v[52:55], v[100:115]
    ds_read_b64_tr_b16 a[48:49], v13 offset:3744
    ds_read_b64_tr_b16 a[50:51], v13 offset:5536
    ds_read_b64_tr_b16 a[52:53], v13 offset:3776
    ds_read_b64_tr_b16 a[54:55], v13 offset:5568
    s_waitcnt vmcnt(5)
    v_lshlrev_b32 v60, 16, v40
    v_mfma_f32_32x32x16_bf16 v[116:131], a[12:15], v[52:55], v[116:131]
    v_and_b32 v61, 4294901760, v40
    v_lshlrev_b32 v62, 16, v41
    v_and_b32 v63, 4294901760, v41
    v_lshlrev_b32 v64, 16, v42
    v_and_b32 v65, 4294901760, v42
    s_waitcnt lgkmcnt(15)
    v_mfma_f32_32x32x16_bf16 v[132:147], a[16:19], v[52:55], v[132:147]
    v_lshlrev_b32 v66, 16, v43
    v_and_b32 v67, 4294901760, v43
    v_fma_f32 v60, v60, v11, v12
    v_fma_f32 v61, v61, v11, v12
    v_fma_f32 v62, v62, v11, v12
    v_mfma_f32_32x32x16_bf16 v[148:163], a[20:23], v[52:55], v[148:163]
    v_fma_f32 v63, v63, v11, v12
    v_fma_f32 v64, v64, v11, v12
    v_fma_f32 v65, v65, v11, v12
    v_fma_f32 v66, v66, v11, v12
    v_fma_f32 v67, v67, v11, v12
    s_waitcnt lgkmcnt(14)
    v_mfma_f32_32x32x16_bf16 v[164:179], a[24:27], v[52:55], v[164:179]
    v_cvt_pk_bf16_f32 v56, v60, v61
    v_cvt_pk_bf16_f32 v57, v62, v63
    v_cvt_pk_bf16_f32 v58, v64, v65
    v_cvt_pk_bf16_f32 v59, v66, v67
    s_add_u32 s35, s40, 21504
    buffer_load_dwordx4 v[48:51], v3, s[12:15], s35 offen
    s_waitcnt lgkmcnt(12)
    v_mfma_f32_32x32x16_bf16 v[68:83], a[28:31], v[56:59], v[68:83]
    s_barrier
    v_add_u32 v14, 0, v15
    s_add_u32 s36, s45, 57856
    s_mov_b32 m0, s36
    s_add_u32 s35, s38, 1605632
    buffer_load_dwordx4 v16, s[56:59], s35 offen lds
    s_add_u32 s36, s47, 57856
    s_mov_b32 m0, s36
    s_add_u32 s35, s38, 1605632
    buffer_load_dwordx4 v17, s[60:63], s35 offen lds
    s_add_u32 s36, s49, 57856
    s_mov_b32 m0, s36
    s_add_u32 s35, s38, 1605632
    buffer_load_dwordx4 v18, s[64:67], s35 offen lds
    s_add_u32 s36, s51, 57856
    s_mov_b32 m0, s36
    s_add_u32 s35, s38, 1605632
    buffer_load_dwordx4 v19, s[68:71], s35 offen lds
    ds_read_b64_tr_b16 a[0:1], v14
    ds_read_b64_tr_b16 a[2:3], v14 offset:1792
    ds_read_b64_tr_b16 a[4:5], v14 offset:32
    ds_read_b64_tr_b16 a[6:7], v14 offset:1824
    s_waitcnt lgkmcnt(14)
    v_mfma_f32_32x32x16_bf16 v[84:99], a[32:35], v[56:59], v[84:99]
    ds_read_b64_tr_b16 a[8:9], v14 offset:64
    ds_read_b64_tr_b16 a[10:11], v14 offset:1856
    ds_read_b64_tr_b16 a[12:13], v14 offset:96
    ds_read_b64_tr_b16 a[14:15], v14 offset:1888
    ds_read_b64_tr_b16 a[16:17], v14 offset:128
    s_waitcnt lgkmcnt(15)
    v_mfma_f32_32x32x16_bf16 v[100:115], a[36:39], v[56:59], v[100:115]
    ds_read_b64_tr_b16 a[18:19], v14 offset:1920
    ds_read_b64_tr_b16 a[20:21], v14 offset:160
    ds_read_b64_tr_b16 a[22:23], v14 offset:1952
    ds_read_b64_tr_b16 a[24:25], v14 offset:192
    ds_read_b64_tr_b16 a[26:27], v14 offset:1984
    v_mfma_f32_32x32x16_bf16 v[116:131], a[40:43], v[56:59], v[116:131]
    s_waitcnt vmcnt(5)
    v_lshlrev_b32 v60, 16, v44
    v_and_b32 v61, 4294901760, v44
    v_lshlrev_b32 v62, 16, v45
    v_and_b32 v63, 4294901760, v45
    v_lshlrev_b32 v64, 16, v46
    v_and_b32 v65, 4294901760, v46
    s_waitcnt lgkmcnt(15)
    v_mfma_f32_32x32x16_bf16 v[132:147], a[44:47], v[56:59], v[132:147]
    v_lshlrev_b32 v66, 16, v47
    v_and_b32 v67, 4294901760, v47
    v_fma_f32 v60, v60, v11, v12
    v_fma_f32 v61, v61, v11, v12
    v_fma_f32 v62, v62, v11, v12
    v_mfma_f32_32x32x16_bf16 v[148:163], a[48:51], v[56:59], v[148:163]
    v_fma_f32 v63, v63, v11, v12
    v_fma_f32 v64, v64, v11, v12
    v_fma_f32 v65, v65, v11, v12
    v_fma_f32 v66, v66, v11, v12
    v_fma_f32 v67, v67, v11, v12
    s_waitcnt lgkmcnt(14)
    v_mfma_f32_32x32x16_bf16 v[164:179], a[52:55], v[56:59], v[164:179]
    v_cvt_pk_bf16_f32 v52, v60, v61
    v_cvt_pk_bf16_f32 v53, v62, v63
    v_cvt_pk_bf16_f32 v54, v64, v65
    v_cvt_pk_bf16_f32 v55, v66, v67
    s_add_u32 s35, s40, 24576
    buffer_load_dwordx4 v[36:39], v3, s[12:15], s35 offen
    s_waitcnt lgkmcnt(12)
    v_mfma_f32_32x32x16_bf16 v[68:83], a[0:3], v[52:55], v[68:83]
    ds_read_b64_tr_b16 a[28:29], v14 offset:3584
    ds_read_b64_tr_b16 a[30:31], v14 offset:5376
    ds_read_b64_tr_b16 a[32:33], v14 offset:3616
    ds_read_b64_tr_b16 a[34:35], v14 offset:5408
    ds_read_b64_tr_b16 a[36:37], v14 offset:3648
    s_waitcnt lgkmcnt(15)
    v_mfma_f32_32x32x16_bf16 v[84:99], a[4:7], v[52:55], v[84:99]
    ds_read_b64_tr_b16 a[38:39], v14 offset:5440
    ds_read_b64_tr_b16 a[40:41], v14 offset:3680
    ds_read_b64_tr_b16 a[42:43], v14 offset:5472
    ds_read_b64_tr_b16 a[44:45], v14 offset:3712
    ds_read_b64_tr_b16 a[46:47], v14 offset:5504
    s_waitcnt lgkmcnt(15)
    v_mfma_f32_32x32x16_bf16 v[100:115], a[8:11], v[52:55], v[100:115]
    ds_read_b64_tr_b16 a[48:49], v14 offset:3744
    ds_read_b64_tr_b16 a[50:51], v14 offset:5536
    ds_read_b64_tr_b16 a[52:53], v14 offset:3776
    ds_read_b64_tr_b16 a[54:55], v14 offset:5568
    s_waitcnt vmcnt(5)
    v_lshlrev_b32 v60, 16, v48
    v_mfma_f32_32x32x16_bf16 v[116:131], a[12:15], v[52:55], v[116:131]
    v_and_b32 v61, 4294901760, v48
    v_lshlrev_b32 v62, 16, v49
    v_and_b32 v63, 4294901760, v49
    v_lshlrev_b32 v64, 16, v50
    v_and_b32 v65, 4294901760, v50
    s_waitcnt lgkmcnt(15)
    v_mfma_f32_32x32x16_bf16 v[132:147], a[16:19], v[52:55], v[132:147]
    v_lshlrev_b32 v66, 16, v51
    v_and_b32 v67, 4294901760, v51
    v_fma_f32 v60, v60, v11, v12
    v_fma_f32 v61, v61, v11, v12
    v_fma_f32 v62, v62, v11, v12
    v_mfma_f32_32x32x16_bf16 v[148:163], a[20:23], v[52:55], v[148:163]
    v_fma_f32 v63, v63, v11, v12
    v_fma_f32 v64, v64, v11, v12
    v_fma_f32 v65, v65, v11, v12
    v_fma_f32 v66, v66, v11, v12
    v_fma_f32 v67, v67, v11, v12
    s_waitcnt lgkmcnt(14)
    v_mfma_f32_32x32x16_bf16 v[164:179], a[24:27], v[52:55], v[164:179]
    v_cvt_pk_bf16_f32 v56, v60, v61
    v_cvt_pk_bf16_f32 v57, v62, v63
    v_cvt_pk_bf16_f32 v58, v64, v65
    v_cvt_pk_bf16_f32 v59, v66, v67
    s_add_u32 s35, s40, 25600
    buffer_load_dwordx4 v[40:43], v3, s[12:15], s35 offen
    s_waitcnt lgkmcnt(12)
    v_mfma_f32_32x32x16_bf16 v[68:83], a[28:31], v[56:59], v[68:83]
    s_barrier
    v_add_u32 v13, 28928, v15
    ds_read_b64_tr_b16 a[0:1], v13
    ds_read_b64_tr_b16 a[2:3], v13 offset:1792
    ds_read_b64_tr_b16 a[4:5], v13 offset:32
    ds_read_b64_tr_b16 a[6:7], v13 offset:1824
    ds_read_b64_tr_b16 a[8:9], v13 offset:64
    s_waitcnt lgkmcnt(15)
    v_mfma_f32_32x32x16_bf16 v[84:99], a[32:35], v[56:59], v[84:99]
    ds_read_b64_tr_b16 a[10:11], v13 offset:1856
    ds_read_b64_tr_b16 a[12:13], v13 offset:96
    ds_read_b64_tr_b16 a[14:15], v13 offset:1888
    ds_read_b64_tr_b16 a[16:17], v13 offset:128
    ds_read_b64_tr_b16 a[18:19], v13 offset:1920
    s_waitcnt lgkmcnt(15)
    v_mfma_f32_32x32x16_bf16 v[100:115], a[36:39], v[56:59], v[100:115]
    ds_read_b64_tr_b16 a[20:21], v13 offset:160
    ds_read_b64_tr_b16 a[22:23], v13 offset:1952
    ds_read_b64_tr_b16 a[24:25], v13 offset:192
    ds_read_b64_tr_b16 a[26:27], v13 offset:1984
    s_waitcnt vmcnt(1)
    v_lshlrev_b32 v60, 16, v36
    v_mfma_f32_32x32x16_bf16 v[116:131], a[40:43], v[56:59], v[116:131]
    v_and_b32 v61, 4294901760, v36
    v_lshlrev_b32 v62, 16, v37
    v_and_b32 v63, 4294901760, v37
    v_lshlrev_b32 v64, 16, v38
    v_and_b32 v65, 4294901760, v38
    s_waitcnt lgkmcnt(15)
    v_mfma_f32_32x32x16_bf16 v[132:147], a[44:47], v[56:59], v[132:147]
    v_lshlrev_b32 v66, 16, v39
    v_and_b32 v67, 4294901760, v39
    v_fma_f32 v60, v60, v11, v12
    v_fma_f32 v61, v61, v11, v12
    v_fma_f32 v62, v62, v11, v12
    v_mfma_f32_32x32x16_bf16 v[148:163], a[48:51], v[56:59], v[148:163]
    v_fma_f32 v63, v63, v11, v12
    v_fma_f32 v64, v64, v11, v12
    v_fma_f32 v65, v65, v11, v12
    v_fma_f32 v66, v66, v11, v12
    v_fma_f32 v67, v67, v11, v12
    s_waitcnt lgkmcnt(14)
    v_mfma_f32_32x32x16_bf16 v[164:179], a[52:55], v[56:59], v[164:179]
    v_cvt_pk_bf16_f32 v52, v60, v61
    v_cvt_pk_bf16_f32 v53, v62, v63
    v_cvt_pk_bf16_f32 v54, v64, v65
    v_cvt_pk_bf16_f32 v55, v66, v67
    s_add_u32 s35, s40, 28672
    buffer_load_dwordx4 v[44:47], v3, s[12:15], s35 offen
    s_waitcnt lgkmcnt(12)
    v_mfma_f32_32x32x16_bf16 v[68:83], a[0:3], v[52:55], v[68:83]
    ds_read_b64_tr_b16 a[28:29], v13 offset:3584
    ds_read_b64_tr_b16 a[30:31], v13 offset:5376
    ds_read_b64_tr_b16 a[32:33], v13 offset:3616
    ds_read_b64_tr_b16 a[34:35], v13 offset:5408
    ds_read_b64_tr_b16 a[36:37], v13 offset:3648
    s_waitcnt lgkmcnt(15)
    v_mfma_f32_32x32x16_bf16 v[84:99], a[4:7], v[52:55], v[84:99]
    ds_read_b64_tr_b16 a[38:39], v13 offset:5440
    ds_read_b64_tr_b16 a[40:41], v13 offset:3680
    ds_read_b64_tr_b16 a[42:43], v13 offset:5472
    ds_read_b64_tr_b16 a[44:45], v13 offset:3712
    ds_read_b64_tr_b16 a[46:47], v13 offset:5504
    s_waitcnt lgkmcnt(15)
    v_mfma_f32_32x32x16_bf16 v[100:115], a[8:11], v[52:55], v[100:115]
    ds_read_b64_tr_b16 a[48:49], v13 offset:3744
    ds_read_b64_tr_b16 a[50:51], v13 offset:5536
    ds_read_b64_tr_b16 a[52:53], v13 offset:3776
    ds_read_b64_tr_b16 a[54:55], v13 offset:5568
    s_waitcnt vmcnt(1)
    v_lshlrev_b32 v60, 16, v40
    v_mfma_f32_32x32x16_bf16 v[116:131], a[12:15], v[52:55], v[116:131]
    v_and_b32 v61, 4294901760, v40
    v_lshlrev_b32 v62, 16, v41
    v_and_b32 v63, 4294901760, v41
    v_lshlrev_b32 v64, 16, v42
    v_and_b32 v65, 4294901760, v42
    s_waitcnt lgkmcnt(15)
    v_mfma_f32_32x32x16_bf16 v[132:147], a[16:19], v[52:55], v[132:147]
    v_lshlrev_b32 v66, 16, v43
    v_and_b32 v67, 4294901760, v43
    v_fma_f32 v60, v60, v11, v12
    v_fma_f32 v61, v61, v11, v12
    v_fma_f32 v62, v62, v11, v12
    v_mfma_f32_32x32x16_bf16 v[148:163], a[20:23], v[52:55], v[148:163]
    v_fma_f32 v63, v63, v11, v12
    v_fma_f32 v64, v64, v11, v12
    v_fma_f32 v65, v65, v11, v12
    v_fma_f32 v66, v66, v11, v12
    v_fma_f32 v67, v67, v11, v12
    s_waitcnt lgkmcnt(14)
    v_mfma_f32_32x32x16_bf16 v[164:179], a[24:27], v[52:55], v[164:179]
    v_cvt_pk_bf16_f32 v56, v60, v61
    v_cvt_pk_bf16_f32 v57, v62, v63
    v_cvt_pk_bf16_f32 v58, v64, v65
    v_cvt_pk_bf16_f32 v59, v66, v67
    s_add_u32 s35, s40, 29696
    buffer_load_dwordx4 v[48:51], v3, s[12:15], s35 offen
    s_waitcnt lgkmcnt(12)
    v_mfma_f32_32x32x16_bf16 v[68:83], a[28:31], v[56:59], v[68:83]
    s_barrier
    v_add_u32 v14, 57856, v15
    ds_read_b64_tr_b16 a[0:1], v14
    ds_read_b64_tr_b16 a[2:3], v14 offset:1792
    ds_read_b64_tr_b16 a[4:5], v14 offset:32
    ds_read_b64_tr_b16 a[6:7], v14 offset:1824
    s_waitcnt lgkmcnt(14)
    v_mfma_f32_32x32x16_bf16 v[84:99], a[32:35], v[56:59], v[84:99]
    ds_read_b64_tr_b16 a[8:9], v14 offset:64
    ds_read_b64_tr_b16 a[10:11], v14 offset:1856
    ds_read_b64_tr_b16 a[12:13], v14 offset:96
    ds_read_b64_tr_b16 a[14:15], v14 offset:1888
    ds_read_b64_tr_b16 a[16:17], v14 offset:128
    s_waitcnt lgkmcnt(15)
    v_mfma_f32_32x32x16_bf16 v[100:115], a[36:39], v[56:59], v[100:115]
    ds_read_b64_tr_b16 a[18:19], v14 offset:1920
    ds_read_b64_tr_b16 a[20:21], v14 offset:160
    ds_read_b64_tr_b16 a[22:23], v14 offset:1952
    ds_read_b64_tr_b16 a[24:25], v14 offset:192
    ds_read_b64_tr_b16 a[26:27], v14 offset:1984
    v_mfma_f32_32x32x16_bf16 v[116:131], a[40:43], v[56:59], v[116:131]
    s_waitcnt vmcnt(1)
    v_lshlrev_b32 v60, 16, v44
    v_and_b32 v61, 4294901760, v44
    v_lshlrev_b32 v62, 16, v45
    v_and_b32 v63, 4294901760, v45
    v_lshlrev_b32 v64, 16, v46
    s_waitcnt lgkmcnt(15)
    v_mfma_f32_32x32x16_bf16 v[132:147], a[44:47], v[56:59], v[132:147]
    v_and_b32 v65, 4294901760, v46
    v_lshlrev_b32 v66, 16, v47
    v_and_b32 v67, 4294901760, v47
    v_fma_f32 v60, v60, v11, v12
    v_fma_f32 v61, v61, v11, v12
    v_mfma_f32_32x32x16_bf16 v[148:163], a[48:51], v[56:59], v[148:163]
    v_fma_f32 v62, v62, v11, v12
    v_fma_f32 v63, v63, v11, v12
    v_fma_f32 v64, v64, v11, v12
    v_fma_f32 v65, v65, v11, v12
    v_fma_f32 v66, v66, v11, v12
    s_waitcnt lgkmcnt(14)
    v_mfma_f32_32x32x16_bf16 v[164:179], a[52:55], v[56:59], v[164:179]
    v_fma_f32 v67, v67, v11, v12
    v_cvt_pk_bf16_f32 v52, v60, v61
    v_cvt_pk_bf16_f32 v53, v62, v63
    v_cvt_pk_bf16_f32 v54, v64, v65
    v_cvt_pk_bf16_f32 v55, v66, v67
    s_waitcnt lgkmcnt(12)
    s_nop 0
    v_mfma_f32_32x32x16_bf16 v[68:83], a[0:3], v[52:55], v[68:83]
    ds_read_b64_tr_b16 a[28:29], v14 offset:3584
    ds_read_b64_tr_b16 a[30:31], v14 offset:5376
    ds_read_b64_tr_b16 a[32:33], v14 offset:3616
    ds_read_b64_tr_b16 a[34:35], v14 offset:5408
    ds_read_b64_tr_b16 a[36:37], v14 offset:3648
    s_waitcnt lgkmcnt(15)
    v_mfma_f32_32x32x16_bf16 v[84:99], a[4:7], v[52:55], v[84:99]
    ds_read_b64_tr_b16 a[38:39], v14 offset:5440
    ds_read_b64_tr_b16 a[40:41], v14 offset:3680
    ds_read_b64_tr_b16 a[42:43], v14 offset:5472
    ds_read_b64_tr_b16 a[44:45], v14 offset:3712
    ds_read_b64_tr_b16 a[46:47], v14 offset:5504
    s_waitcnt lgkmcnt(15)
    v_mfma_f32_32x32x16_bf16 v[100:115], a[8:11], v[52:55], v[100:115]
    ds_read_b64_tr_b16 a[48:49], v14 offset:3744
    ds_read_b64_tr_b16 a[50:51], v14 offset:5536
    ds_read_b64_tr_b16 a[52:53], v14 offset:3776
    ds_read_b64_tr_b16 a[54:55], v14 offset:5568
    s_waitcnt vmcnt(0)
    v_lshlrev_b32 v60, 16, v48
    v_mfma_f32_32x32x16_bf16 v[116:131], a[12:15], v[52:55], v[116:131]
    v_and_b32 v61, 4294901760, v48
    v_lshlrev_b32 v62, 16, v49
    v_and_b32 v63, 4294901760, v49
    v_lshlrev_b32 v64, 16, v50
    v_and_b32 v65, 4294901760, v50
    s_waitcnt lgkmcnt(15)
    v_mfma_f32_32x32x16_bf16 v[132:147], a[16:19], v[52:55], v[132:147]
    v_lshlrev_b32 v66, 16, v51
    v_and_b32 v67, 4294901760, v51
    v_fma_f32 v60, v60, v11, v12
    v_fma_f32 v61, v61, v11, v12
    v_fma_f32 v62, v62, v11, v12
    v_mfma_f32_32x32x16_bf16 v[148:163], a[20:23], v[52:55], v[148:163]
    v_fma_f32 v63, v63, v11, v12
    v_fma_f32 v64, v64, v11, v12
    v_fma_f32 v65, v65, v11, v12
    v_fma_f32 v66, v66, v11, v12
    v_fma_f32 v67, v67, v11, v12
    s_waitcnt lgkmcnt(14)
    v_mfma_f32_32x32x16_bf16 v[164:179], a[24:27], v[52:55], v[164:179]
    v_cvt_pk_bf16_f32 v56, v60, v61
    v_cvt_pk_bf16_f32 v57, v62, v63
    v_cvt_pk_bf16_f32 v58, v64, v65
    v_cvt_pk_bf16_f32 v59, v66, v67
    s_waitcnt lgkmcnt(12)
    s_nop 0
    v_mfma_f32_32x32x16_bf16 v[68:83], a[28:31], v[56:59], v[68:83]
    s_waitcnt lgkmcnt(10)
    v_mfma_f32_32x32x16_bf16 v[84:99], a[32:35], v[56:59], v[84:99]
    s_waitcnt lgkmcnt(8)
    v_mfma_f32_32x32x16_bf16 v[100:115], a[36:39], v[56:59], v[100:115]
    s_waitcnt lgkmcnt(6)
    v_mfma_f32_32x32x16_bf16 v[116:131], a[40:43], v[56:59], v[116:131]
    s_waitcnt lgkmcnt(4)
    v_mfma_f32_32x32x16_bf16 v[132:147], a[44:47], v[56:59], v[132:147]
    s_waitcnt lgkmcnt(2)
    v_mfma_f32_32x32x16_bf16 v[148:163], a[48:51], v[56:59], v[148:163]
    s_waitcnt lgkmcnt(0)
    v_mfma_f32_32x32x16_bf16 v[164:179], a[52:55], v[56:59], v[164:179]
    s_barrier
    v_lshl_add_u32 v5, v2, 14, v3
    s_nop 15
    s_cmp_eq_u32 s44, 0
    s_cbranch_scc1 k3_ffn1_kernel_x0
    ds_write_b128 v5, v[68:71]
    ds_write_b128 v5, v[72:75] offset:1024
    ds_write_b128 v5, v[76:79] offset:2048
    ds_write_b128 v5, v[80:83] offset:3072
    ds_write_b128 v5, v[84:87] offset:4096
    ds_write_b128 v5, v[88:91] offset:5120
    ds_write_b128 v5, v[92:95] offset:6144
    ds_write_b128 v5, v[96:99] offset:7168
    ds_write_b128 v5, v[100:103] offset:8192
    ds_write_b128 v5, v[104:107] offset:9216
    ds_write_b128 v5, v[108:111] offset:10240
    ds_write_b128 v5, v[112:115] offset:11264
    ds_write_b128 v5, v[116:119] offset:12288
    ds_write_b128 v5, v[120:123] offset:13312
    ds_write_b128 v5, v[124:127] offset:14336
    ds_write_b128 v5, v[128:131] offset:15360
    s_nop 15
    s_branch k3_ffn1_kernel_x1
k3_ffn1_kernel_x0:
    ds_write_b128 v5, v[132:135]
    ds_write_b128 v5, v[136:139] offset:1024
    ds_write_b128 v5, v[140:143] offset:2048
    ds_write_b128 v5, v[144:147] offset:3072
    ds_write_b128 v5, v[148:151] offset:4096
    ds_write_b128 v5, v[152:155] offset:5120
    ds_write_b128 v5, v[156:159] offset:6144
    ds_write_b128 v5, v[160:163] offset:7168
    ds_write_b128 v5, v[164:167] offset:8192
    ds_write_b128 v5, v[168:171] offset:9216
    ds_write_b128 v5, v[172:175] offset:10240
    ds_write_b128 v5, v[176:179] offset:11264
    s_nop 15
k3_ffn1_kernel_x1:
    s_waitcnt lgkmcnt(0)
    s_barrier
    v_xor_b32 v6, 65536, v5
    s_mov_b32 s41, 3216550459
    s_mul_i32 s42, s37, 112
    s_mul_i32 s35, s34, 7
    s_add_u32 s42, s42, s35
    s_lshl_b32 s42, s42, 10
    s_nop 15
    s_cmp_eq_u32 s44, 0
    s_cbranch_scc1 k3_ffn1_kernel_f0
    ds_read_b128 v[28:31], v6
    ds_read_b128 v[32:35], v6 offset:1024
    ds_read_b128 v[36:39], v6 offset:2048
    ds_read_b128 v[40:43], v6 offset:3072
    s_waitcnt lgkmcnt(3)
    v_add_f32 v132, v132, v28
    v_add_f32 v133, v133, v29
    v_add_f32 v134, v134, v30
    v_add_f32 v135, v135, v31
    s_waitcnt lgkmcnt(2)
    v_add_f32 v136, v136, v32
    v_add_f32 v137, v137, v33
    v_add_f32 v138, v138, v34
    v_add_f32 v139, v139, v35
    s_waitcnt lgkmcnt(1)
    v_add_f32 v140, v140, v36
    v_add_f32 v141, v141, v37
    v_add_f32 v142, v142, v38
    v_add_f32 v143, v143, v39
    s_waitcnt lgkmcnt(0)
    v_add_f32 v144, v144, v40
    v_add_f32 v145, v145, v41
    v_add_f32 v146, v146, v42
    v_add_f32 v147, v147, v43
    v_mul_f32 v20, s41, v132
    v_mul_f32 v21, s41, v133
    v_mul_f32 v22, s41, v134
    v_mul_f32 v23, s41, v135
    v_mul_f32 v24, s41, v136
    v_mul_f32 v25, s41, v137
    v_mul_f32 v26, s41, v138
    v_mul_f32 v27, s41, v139
    v_exp_f32 v20, v20
    v_exp_f32 v21, v21
    v_exp_f32 v22, v22
    v_exp_f32 v23, v23
    v_exp_f32 v24, v24
    v_exp_f32 v25, v25
    v_exp_f32 v26, v26
    v_exp_f32 v27, v27
    v_add_f32 v20, 1.0, v20
    v_add_f32 v21, 1.0, v21
    v_add_f32 v22, 1.0, v22
    v_add_f32 v23, 1.0, v23
    v_add_f32 v24, 1.0, v24
    v_add_f32 v25, 1.0, v25
    v_add_f32 v26, 1.0, v26
    v_add_f32 v27, 1.0, v27
    v_rcp_f32 v20, v20
    v_rcp_f32 v21, v21
    v_rcp_f32 v22, v22
    v_rcp_f32 v23, v23
    v_rcp_f32 v24, v24
    v_rcp_f32 v25, v25
    v_rcp_f32 v26, v26
    v_rcp_f32 v27, v27
    v_mul_f32 v132, v132, v20
    v_mul_f32 v133, v133, v21
    v_mul_f32 v134, v134, v22
    v_mul_f32 v135, v135, v23
    v_mul_f32 v136, v136, v24
    v_mul_f32 v137, v137, v25
    v_mul_f32 v138, v138, v26
    v_mul_f32 v139, v139, v27
    v_mul_f32 v132, v132, v140
    v_mul_f32 v133, v133, v141
    v_mul_f32 v134, v134, v142
    v_mul_f32 v135, v135, v143
    v_mul_f32 v136, v136, v144
    v_mul_f32 v137, v137, v145
    v_mul_f32 v138, v138, v146
    v_mul_f32 v139, v139, v147
    v_cvt_pk_bf16_f32 v132, v132, v133
    v_cvt_pk_bf16_f32 v133, v134, v135
    v_cvt_pk_bf16_f32 v134, v136, v137
    v_cvt_pk_bf16_f32 v135, v138, v139
    s_add_u32 s35, s42, 4096
    buffer_store_dwordx4 v[132:135], v3, s[20:23], s35 offen
    ds_read_b128 v[28:31], v6 offset:4096
    ds_read_b128 v[32:35], v6 offset:5120
    ds_read_b128 v[36:39], v6 offset:6144
    ds_read_b128 v[40:43], v6 offset:7168
    s_waitcnt lgkmcnt(3)
    v_add_f32 v148, v148, v28
    v_add_f32 v149, v149, v29
    v_add_f32 v150, v150, v30
    v_add_f32 v151, v151, v31
    s_waitcnt lgkmcnt(2)
    v_add_f32 v152, v152, v32
    v_add_f32 v153, v153, v33
    v_add_f32 v154, v154, v34
    v_add_f32 v155, v155, v35
    s_waitcnt lgkmcnt(1)
    v_add_f32 v156, v156, v36
    v_add_f32 v157, v157, v37
    v_add_f32 v158, v158, v38
    v_add_f32 v159, v159, v39
    s_waitcnt lgkmcnt(0)
    v_add_f32 v160, v160, v40
    v_add_f32 v161, v161, v41
    v_add_f32 v162, v162, v42
    v_add_f32 v163, v163, v43
    v_mul_f32 v20, s41, v148
    v_mul_f32 v21, s41, v149
    v_mul_f32 v22, s41, v150
    v_mul_f32 v23, s41, v151
    v_mul_f32 v24, s41, v152
    v_mul_f32 v25, s41, v153
    v_mul_f32 v26, s41, v154
    v_mul_f32 v27, s41, v155
    v_exp_f32 v20, v20
    v_exp_f32 v21, v21
    v_exp_f32 v22, v22
    v_exp_f32 v23, v23
    v_exp_f32 v24, v24
    v_exp_f32 v25, v25
    v_exp_f32 v26, v26
    v_exp_f32 v27, v27
    v_add_f32 v20, 1.0, v20
    v_add_f32 v21, 1.0, v21
    v_add_f32 v22, 1.0, v22
    v_add_f32 v23, 1.0, v23
    v_add_f32 v24, 1.0, v24
    v_add_f32 v25, 1.0, v25
    v_add_f32 v26, 1.0, v26
    v_add_f32 v27, 1.0, v27
    v_rcp_f32 v20, v20
    v_rcp_f32 v21, v21
    v_rcp_f32 v22, v22
    v_rcp_f32 v23, v23
    v_rcp_f32 v24, v24
    v_rcp_f32 v25, v25
    v_rcp_f32 v26, v26
    v_rcp_f32 v27, v27
    v_mul_f32 v148, v148, v20
    v_mul_f32 v149, v149, v21
    v_mul_f32 v150, v150, v22
    v_mul_f32 v151, v151, v23
    v_mul_f32 v152, v152, v24
    v_mul_f32 v153, v153, v25
    v_mul_f32 v154, v154, v26
    v_mul_f32 v155, v155, v27
    v_mul_f32 v148, v148, v156
    v_mul_f32 v149, v149, v157
    v_mul_f32 v150, v150, v158
    v_mul_f32 v151, v151, v159
    v_mul_f32 v152, v152, v160
    v_mul_f32 v153, v153, v161
    v_mul_f32 v154, v154, v162
    v_mul_f32 v155, v155, v163
    v_cvt_pk_bf16_f32 v148, v148, v149
    v_cvt_pk_bf16_f32 v149, v150, v151
    v_cvt_pk_bf16_f32 v150, v152, v153
    v_cvt_pk_bf16_f32 v151, v154, v155
    s_add_u32 s35, s42, 5120
    buffer_store_dwordx4 v[148:151], v3, s[20:23], s35 offen
    ds_read_b128 v[28:31], v6 offset:8192
    ds_read_b128 v[32:35], v6 offset:9216
    ds_read_b128 v[36:39], v6 offset:10240
    ds_read_b128 v[40:43], v6 offset:11264
    s_waitcnt lgkmcnt(3)
    v_add_f32 v164, v164, v28
    v_add_f32 v165, v165, v29
    v_add_f32 v166, v166, v30
    v_add_f32 v167, v167, v31
    s_waitcnt lgkmcnt(2)
    v_add_f32 v168, v168, v32
    v_add_f32 v169, v169, v33
    v_add_f32 v170, v170, v34
    v_add_f32 v171, v171, v35
    s_waitcnt lgkmcnt(1)
    v_add_f32 v172, v172, v36
    v_add_f32 v173, v173, v37
    v_add_f32 v174, v174, v38
    v_add_f32 v175, v175, v39
    s_waitcnt lgkmcnt(0)
    v_add_f32 v176, v176, v40
    v_add_f32 v177, v177, v41
    v_add_f32 v178, v178, v42
    v_add_f32 v179, v179, v43
    v_mul_f32 v20, s41, v164
    v_mul_f32 v21, s41, v165
    v_mul_f32 v22, s41, v166
    v_mul_f32 v23, s41, v167
    v_mul_f32 v24, s41, v168
    v_mul_f32 v25, s41, v169
    v_mul_f32 v26, s41, v170
    v_mul_f32 v27, s41, v171
    v_exp_f32 v20, v20
    v_exp_f32 v21, v21
    v_exp_f32 v22, v22
    v_exp_f32 v23, v23
    v_exp_f32 v24, v24
    v_exp_f32 v25, v25
    v_exp_f32 v26, v26
    v_exp_f32 v27, v27
    v_add_f32 v20, 1.0, v20
    v_add_f32 v21, 1.0, v21
    v_add_f32 v22, 1.0, v22
    v_add_f32 v23, 1.0, v23
    v_add_f32 v24, 1.0, v24
    v_add_f32 v25, 1.0, v25
    v_add_f32 v26, 1.0, v26
    v_add_f32 v27, 1.0, v27
    v_rcp_f32 v20, v20
    v_rcp_f32 v21, v21
    v_rcp_f32 v22, v22
    v_rcp_f32 v23, v23
    v_rcp_f32 v24, v24
    v_rcp_f32 v25, v25
    v_rcp_f32 v26, v26
    v_rcp_f32 v27, v27
    v_mul_f32 v164, v164, v20
    v_mul_f32 v165, v165, v21
    v_mul_f32 v166, v166, v22
    v_mul_f32 v167, v167, v23
    v_mul_f32 v168, v168, v24
    v_mul_f32 v169, v169, v25
    v_mul_f32 v170, v170, v26
    v_mul_f32 v171, v171, v27
    v_mul_f32 v164, v164, v172
    v_mul_f32 v165, v165, v173
    v_mul_f32 v166, v166, v174
    v_mul_f32 v167, v167, v175
    v_mul_f32 v168, v168, v176
    v_mul_f32 v169, v169, v177
    v_mul_f32 v170, v170, v178
    v_mul_f32 v171, v171, v179
    v_cvt_pk_bf16_f32 v164, v164, v165
    v_cvt_pk_bf16_f32 v165, v166, v167
    v_cvt_pk_bf16_f32 v166, v168, v169
    v_cvt_pk_bf16_f32 v167, v170, v171
    s_add_u32 s35, s42, 6144
    buffer_store_dwordx4 v[164:167], v3, s[20:23], s35 offen
    s_nop 15
    s_branch k3_ffn1_kernel_f1
k3_ffn1_kernel_f0:
    ds_read_b128 v[28:31], v6
    ds_read_b128 v[32:35], v6 offset:1024
    ds_read_b128 v[36:39], v6 offset:2048
    ds_read_b128 v[40:43], v6 offset:3072
    s_waitcnt lgkmcnt(3)
    v_add_f32 v68, v68, v28
    v_add_f32 v69, v69, v29
    v_add_f32 v70, v70, v30
    v_add_f32 v71, v71, v31
    s_waitcnt lgkmcnt(2)
    v_add_f32 v72, v72, v32
    v_add_f32 v73, v73, v33
    v_add_f32 v74, v74, v34
    v_add_f32 v75, v75, v35
    s_waitcnt lgkmcnt(1)
    v_add_f32 v76, v76, v36
    v_add_f32 v77, v77, v37
    v_add_f32 v78, v78, v38
    v_add_f32 v79, v79, v39
    s_waitcnt lgkmcnt(0)
    v_add_f32 v80, v80, v40
    v_add_f32 v81, v81, v41
    v_add_f32 v82, v82, v42
    v_add_f32 v83, v83, v43
    v_mul_f32 v20, s41, v68
    v_mul_f32 v21, s41, v69
    v_mul_f32 v22, s41, v70
    v_mul_f32 v23, s41, v71
    v_mul_f32 v24, s41, v72
    v_mul_f32 v25, s41, v73
    v_mul_f32 v26, s41, v74
    v_mul_f32 v27, s41, v75
    v_exp_f32 v20, v20
    v_exp_f32 v21, v21
    v_exp_f32 v22, v22
    v_exp_f32 v23, v23
    v_exp_f32 v24, v24
    v_exp_f32 v25, v25
    v_exp_f32 v26, v26
    v_exp_f32 v27, v27
    v_add_f32 v20, 1.0, v20
    v_add_f32 v21, 1.0, v21
    v_add_f32 v22, 1.0, v22
    v_add_f32 v23, 1.0, v23
    v_add_f32 v24, 1.0, v24
    v_add_f32 v25, 1.0, v25
    v_add_f32 v26, 1.0, v26
    v_add_f32 v27, 1.0, v27
    v_rcp_f32 v20, v20
    v_rcp_f32 v21, v21
    v_rcp_f32 v22, v22
    v_rcp_f32 v23, v23
    v_rcp_f32 v24, v24
    v_rcp_f32 v25, v25
    v_rcp_f32 v26, v26
    v_rcp_f32 v27, v27
    v_mul_f32 v68, v68, v20
    v_mul_f32 v69, v69, v21
    v_mul_f32 v70, v70, v22
    v_mul_f32 v71, v71, v23
    v_mul_f32 v72, v72, v24
    v_mul_f32 v73, v73, v25
    v_mul_f32 v74, v74, v26
    v_mul_f32 v75, v75, v27
    v_mul_f32 v68, v68, v76
    v_mul_f32 v69, v69, v77
    v_mul_f32 v70, v70, v78
    v_mul_f32 v71, v71, v79
    v_mul_f32 v72, v72, v80
    v_mul_f32 v73, v73, v81
    v_mul_f32 v74, v74, v82
    v_mul_f32 v75, v75, v83
    v_cvt_pk_bf16_f32 v68, v68, v69
    v_cvt_pk_bf16_f32 v69, v70, v71
    v_cvt_pk_bf16_f32 v70, v72, v73
    v_cvt_pk_bf16_f32 v71, v74, v75
    s_add_u32 s35, s42, 0
    buffer_store_dwordx4 v[68:71], v3, s[20:23], s35 offen
    ds_read_b128 v[28:31], v6 offset:4096
    ds_read_b128 v[32:35], v6 offset:5120
    ds_read_b128 v[36:39], v6 offset:6144
    ds_read_b128 v[40:43], v6 offset:7168
    s_waitcnt lgkmcnt(3)
    v_add_f32 v84, v84, v28
    v_add_f32 v85, v85, v29
    v_add_f32 v86, v86, v30
    v_add_f32 v87, v87, v31
    s_waitcnt lgkmcnt(2)
    v_add_f32 v88, v88, v32
    v_add_f32 v89, v89, v33
    v_add_f32 v90, v90, v34
    v_add_f32 v91, v91, v35
    s_waitcnt lgkmcnt(1)
    v_add_f32 v92, v92, v36
    v_add_f32 v93, v93, v37
    v_add_f32 v94, v94, v38
    v_add_f32 v95, v95, v39
    s_waitcnt lgkmcnt(0)
    v_add_f32 v96, v96, v40
    v_add_f32 v97, v97, v41
    v_add_f32 v98, v98, v42
    v_add_f32 v99, v99, v43
    v_mul_f32 v20, s41, v84
    v_mul_f32 v21, s41, v85
    v_mul_f32 v22, s41, v86
    v_mul_f32 v23, s41, v87
    v_mul_f32 v24, s41, v88
    v_mul_f32 v25, s41, v89
    v_mul_f32 v26, s41, v90
    v_mul_f32 v27, s41, v91
    v_exp_f32 v20, v20
    v_exp_f32 v21, v21
    v_exp_f32 v22, v22
    v_exp_f32 v23, v23
    v_exp_f32 v24, v24
    v_exp_f32 v25, v25
    v_exp_f32 v26, v26
    v_exp_f32 v27, v27
    v_add_f32 v20, 1.0, v20
    v_add_f32 v21, 1.0, v21
    v_add_f32 v22, 1.0, v22
    v_add_f32 v23, 1.0, v23
    v_add_f32 v24, 1.0, v24
    v_add_f32 v25, 1.0, v25
    v_add_f32 v26, 1.0, v26
    v_add_f32 v27, 1.0, v27
    v_rcp_f32 v20, v20
    v_rcp_f32 v21, v21
    v_rcp_f32 v22, v22
    v_rcp_f32 v23, v23
    v_rcp_f32 v24, v24
    v_rcp_f32 v25, v25
    v_rcp_f32 v26, v26
    v_rcp_f32 v27, v27
    v_mul_f32 v84, v84, v20
    v_mul_f32 v85, v85, v21
    v_mul_f32 v86, v86, v22
    v_mul_f32 v87, v87, v23
    v_mul_f32 v88, v88, v24
    v_mul_f32 v89, v89, v25
    v_mul_f32 v90, v90, v26
    v_mul_f32 v91, v91, v27
    v_mul_f32 v84, v84, v92
    v_mul_f32 v85, v85, v93
    v_mul_f32 v86, v86, v94
    v_mul_f32 v87, v87, v95
    v_mul_f32 v88, v88, v96
    v_mul_f32 v89, v89, v97
    v_mul_f32 v90, v90, v98
    v_mul_f32 v91, v91, v99
    v_cvt_pk_bf16_f32 v84, v84, v85
    v_cvt_pk_bf16_f32 v85, v86, v87
    v_cvt_pk_bf16_f32 v86, v88, v89
    v_cvt_pk_bf16_f32 v87, v90, v91
    s_add_u32 s35, s42, 1024
    buffer_store_dwordx4 v[84:87], v3, s[20:23], s35 offen
    ds_read_b128 v[28:31], v6 offset:8192
    ds_read_b128 v[32:35], v6 offset:9216
    ds_read_b128 v[36:39], v6 offset:10240
    ds_read_b128 v[40:43], v6 offset:11264
    s_waitcnt lgkmcnt(3)
    v_add_f32 v100, v100, v28
    v_add_f32 v101, v101, v29
    v_add_f32 v102, v102, v30
    v_add_f32 v103, v103, v31
    s_waitcnt lgkmcnt(2)
    v_add_f32 v104, v104, v32
    v_add_f32 v105, v105, v33
    v_add_f32 v106, v106, v34
    v_add_f32 v107, v107, v35
    s_waitcnt lgkmcnt(1)
    v_add_f32 v108, v108, v36
    v_add_f32 v109, v109, v37
    v_add_f32 v110, v110, v38
    v_add_f32 v111, v111, v39
    s_waitcnt lgkmcnt(0)
    v_add_f32 v112, v112, v40
    v_add_f32 v113, v113, v41
    v_add_f32 v114, v114, v42
    v_add_f32 v115, v115, v43
    v_mul_f32 v20, s41, v100
    v_mul_f32 v21, s41, v101
    v_mul_f32 v22, s41, v102
    v_mul_f32 v23, s41, v103
    v_mul_f32 v24, s41, v104
    v_mul_f32 v25, s41, v105
    v_mul_f32 v26, s41, v106
    v_mul_f32 v27, s41, v107
    v_exp_f32 v20, v20
    v_exp_f32 v21, v21
    v_exp_f32 v22, v22
    v_exp_f32 v23, v23
    v_exp_f32 v24, v24
    v_exp_f32 v25, v25
    v_exp_f32 v26, v26
    v_exp_f32 v27, v27
    v_add_f32 v20, 1.0, v20
    v_add_f32 v21, 1.0, v21
    v_add_f32 v22, 1.0, v22
    v_add_f32 v23, 1.0, v23
    v_add_f32 v24, 1.0, v24
    v_add_f32 v25, 1.0, v25
    v_add_f32 v26, 1.0, v26
    v_add_f32 v27, 1.0, v27
    v_rcp_f32 v20, v20
    v_rcp_f32 v21, v21
    v_rcp_f32 v22, v22
    v_rcp_f32 v23, v23
    v_rcp_f32 v24, v24
    v_rcp_f32 v25, v25
    v_rcp_f32 v26, v26
    v_rcp_f32 v27, v27
    v_mul_f32 v100, v100, v20
    v_mul_f32 v101, v101, v21
    v_mul_f32 v102, v102, v22
    v_mul_f32 v103, v103, v23
    v_mul_f32 v104, v104, v24
    v_mul_f32 v105, v105, v25
    v_mul_f32 v106, v106, v26
    v_mul_f32 v107, v107, v27
    v_mul_f32 v100, v100, v108
    v_mul_f32 v101, v101, v109
    v_mul_f32 v102, v102, v110
    v_mul_f32 v103, v103, v111
    v_mul_f32 v104, v104, v112
    v_mul_f32 v105, v105, v113
    v_mul_f32 v106, v106, v114
    v_mul_f32 v107, v107, v115
    v_cvt_pk_bf16_f32 v100, v100, v101
    v_cvt_pk_bf16_f32 v101, v102, v103
    v_cvt_pk_bf16_f32 v102, v104, v105
    v_cvt_pk_bf16_f32 v103, v106, v107
    s_add_u32 s35, s42, 2048
    buffer_store_dwordx4 v[100:103], v3, s[20:23], s35 offen
    ds_read_b128 v[28:31], v6 offset:12288
    ds_read_b128 v[32:35], v6 offset:13312
    ds_read_b128 v[36:39], v6 offset:14336
    ds_read_b128 v[40:43], v6 offset:15360
    s_waitcnt lgkmcnt(3)
    v_add_f32 v116, v116, v28
    v_add_f32 v117, v117, v29
    v_add_f32 v118, v118, v30
    v_add_f32 v119, v119, v31
    s_waitcnt lgkmcnt(2)
    v_add_f32 v120, v120, v32
    v_add_f32 v121, v121, v33
    v_add_f32 v122, v122, v34
    v_add_f32 v123, v123, v35
    s_waitcnt lgkmcnt(1)
    v_add_f32 v124, v124, v36
    v_add_f32 v125, v125, v37
    v_add_f32 v126, v126, v38
    v_add_f32 v127, v127, v39
    s_waitcnt lgkmcnt(0)
    v_add_f32 v128, v128, v40
    v_add_f32 v129, v129, v41
    v_add_f32 v130, v130, v42
    v_add_f32 v131, v131, v43
    v_mul_f32 v20, s41, v116
    v_mul_f32 v21, s41, v117
    v_mul_f32 v22, s41, v118
    v_mul_f32 v23, s41, v119
    v_mul_f32 v24, s41, v120
    v_mul_f32 v25, s41, v121
    v_mul_f32 v26, s41, v122
    v_mul_f32 v27, s41, v123
    v_exp_f32 v20, v20
    v_exp_f32 v21, v21
    v_exp_f32 v22, v22
    v_exp_f32 v23, v23
    v_exp_f32 v24, v24
    v_exp_f32 v25, v25
    v_exp_f32 v26, v26
    v_exp_f32 v27, v27
    v_add_f32 v20, 1.0, v20
    v_add_f32 v21, 1.0, v21
    v_add_f32 v22, 1.0, v22
    v_add_f32 v23, 1.0, v23
    v_add_f32 v24, 1.0, v24
    v_add_f32 v25, 1.0, v25
    v_add_f32 v26, 1.0, v26
    v_add_f32 v27, 1.0, v27
    v_rcp_f32 v20, v20
    v_rcp_f32 v21, v21
    v_rcp_f32 v22, v22
    v_rcp_f32 v23, v23
    v_rcp_f32 v24, v24
    v_rcp_f32 v25, v25
    v_rcp_f32 v26, v26
    v_rcp_f32 v27, v27
    v_mul_f32 v116, v116, v20
    v_mul_f32 v117, v117, v21
    v_mul_f32 v118, v118, v22
    v_mul_f32 v119, v119, v23
    v_mul_f32 v120, v120, v24
    v_mul_f32 v121, v121, v25
    v_mul_f32 v122, v122, v26
    v_mul_f32 v123, v123, v27
    v_mul_f32 v116, v116, v124
    v_mul_f32 v117, v117, v125
    v_mul_f32 v118, v118, v126
    v_mul_f32 v119, v119, v127
    v_mul_f32 v120, v120, v128
    v_mul_f32 v121, v121, v129
    v_mul_f32 v122, v122, v130
    v_mul_f32 v123, v123, v131
    v_cvt_pk_bf16_f32 v116, v116, v117
    v_cvt_pk_bf16_f32 v117, v118, v119
    v_cvt_pk_bf16_f32 v118, v120, v121
    v_cvt_pk_bf16_f32 v119, v122, v123
    s_add_u32 s35, s42, 3072
    buffer_store_dwordx4 v[116:119], v3, s[20:23], s35 offen
    s_nop 15
k3_ffn1_kernel_f1:
k3_ffn1_kernel_end:
    s_endpgm
.globl k4_ffn2_kernel
.p2align 8
.type k4_ffn2_kernel,@function
k4_ffn2_kernel:
    s_cmp_ge_u32 s2, 256
    s_cbranch_scc1 k4_ffn2_kernel_end
    s_load_dwordx2 s[4:5], s[0:1], 80
    s_load_dwordx2 s[6:7], s[0:1], 56
    s_load_dwordx2 s[8:9], s[0:1], 64
    v_and_b32 v1, 63, v0
    v_lshrrev_b32 v2, 6, v0
    s_nop 0
    v_readfirstlane_b32 s32, v2
    s_lshr_b32 s33, s2, 5
    s_and_b32 s34, s2, 31
    v_lshrrev_b32 v8, 2, v1
    v_lshlrev_b32 v3, 10, v8
    v_and_b32 v9, 3, v1
    v_lshl_add_u32 v3, v9, 4, v3
    v_lshlrev_b32 v4, 4, v1
    v_lshrrev_b32 v8, 5, v1
    v_lshlrev_b32 v8, 2, v8
    v_bfe_u32 v9, v1, 2, 2
    v_add_u32 v8, v8, v9
    v_lshlrev_b32 v5, 6, v8
    v_bfe_u32 v8, v1, 4, 1
    v_lshl_add_u32 v5, v8, 5, v5
    v_and_b32 v9, 3, v1
    v_lshl_add_u32 v5, v9, 3, v5
    s_lshl_b32 s37, s32, 14
    v_add_u32 v5, s37, v5
    s_waitcnt lgkmcnt(0)
    s_mov_b32 s16, s6
    s_mov_b32 s17, s7
    s_mov_b32 s18, 1835008
    s_mov_b32 s19, 131072
    s_add_u32 s12, s4, 16777216
    s_addc_u32 s13, s5, 0
    s_mov_b32 s14, 7340032
    s_mov_b32 s15, 131072
    s_mul_i32 s38, s32, 229376
    s_lshl_b32 s35, s33, 7
    s_add_u32 s38, s38, s35
    s_lshl_b32 s39, s34, 1
    s_mul_i32 s39, s39, 112
    s_mul_i32 s35, s32, 14
    s_add_u32 s39, s39, s35
    s_lshl_b32 s39, s39, 10
    s_add_u32 s40, s39, 114688
    s_mul_i32 s45, s33, 14
    s_lshr_b32 s45, s45, 3
    s_add_u32 s46, s45, 0
    s_cmp_ge_u32 s46, 14
    s_cselect_b32 s47, 14, 0
    s_sub_u32 s46, s46, s47
    s_lshl_b32 s47, s46, 14
    s_add_u32 s47, s47, s38
    s_add_u32 s36, s37, 0
    s_mov_b32 m0, s36
    s_add_u32 s35, s47, 0
    buffer_load_dwordx4 v3, s[16:19], s35 offen lds
    s_add_u32 s36, s37, 1024
    s_mov_b32 m0, s36
    s_add_u32 s35, s47, 64
    buffer_load_dwordx4 v3, s[16:19], s35 offen lds
    s_add_u32 s46, s45, 0
    s_cmp_ge_u32 s46, 14
    s_cselect_b32 s47, 14, 0
    s_sub_u32 s46, s46, s47
    s_lshl_b32 s47, s46, 10
    s_add_u32 s35, s39, s47
    buffer_load_dwordx4 v[16:19], v4, s[12:15], s35 offen
    s_add_u32 s35, s40, s47
    buffer_load_dwordx4 v[20:23], v4, s[12:15], s35 offen
    s_add_u32 s46, s45, 1
    s_cmp_ge_u32 s46, 14
    s_cselect_b32 s47, 14, 0
    s_sub_u32 s46, s46, s47
    s_lshl_b32 s47, s46, 14
    s_add_u32 s47, s47, s38
    s_add_u32 s36, s37, 2048
    s_mov_b32 m0, s36
    s_add_u32 s35, s47, 0
    buffer_load_dwordx4 v3, s[16:19], s35 offen lds
    s_add_u32 s36, s37, 3072
    s_mov_b32 m0, s36
    s_add_u32 s35, s47, 64
    buffer_load_dwordx4 v3, s[16:19], s35 offen lds
    s_add_u32 s46, s45, 1
    s_cmp_ge_u32 s46, 14
    s_cselect_b32 s47, 14, 0
    s_sub_u32 s46, s46, s47
    s_lshl_b32 s47, s46, 10
    s_add_u32 s35, s39, s47
    buffer_load_dwordx4 v[24:27], v4, s[12:15], s35 offen
    s_add_u32 s35, s40, s47
    buffer_load_dwordx4 v[28:31], v4, s[12:15], s35 offen
    s_add_u32 s46, s45, 2
    s_cmp_ge_u32 s46, 14
    s_cselect_b32 s47, 14, 0
    s_sub_u32 s46, s46, s47
    s_lshl_b32 s47, s46, 14
    s_add_u32 s47, s47, s38
    s_add_u32 s36, s37, 4096
    s_mov_b32 m0, s36
    s_add_u32 s35, s47, 0
    buffer_load_dwordx4 v3, s[16:19], s35 offen lds
    s_add_u32 s36, s37, 5120
    s_mov_b32 m0, s36
    s_add_u32 s35, s47, 64
    buffer_load_dwordx4 v3, s[16:19], s35 offen lds
    s_add_u32 s46, s45, 2
    s_cmp_ge_u32 s46, 14
    s_cselect_b32 s47, 14, 0
    s_sub_u32 s46, s46, s47
    s_lshl_b32 s47, s46, 10
    s_add_u32 s35, s39, s47
    buffer_load_dwordx4 v[32:35], v4, s[12:15], s35 offen
    s_add_u32 s35, s40, s47
    buffer_load_dwordx4 v[36:39], v4, s[12:15], s35 offen
    s_add_u32 s20, s4, 12582912
    s_addc_u32 s21, s5, 0
    s_mov_b32 s22, 2097152
    s_mov_b32 s23, 131072
    s_mov_b32 s24, s8
    s_mov_b32 s25, s9
    s_mov_b32 s26, 2097152
    s_mov_b32 s27, 131072
    v_mov_b32 v64, 0
    v_mov_b32 v65, 0
    v_mov_b32 v66, 0
    v_mov_b32 v67, 0
    v_mov_b32 v68, 0
    v_mov_b32 v69, 0
    v_mov_b32 v70, 0
    v_mov_b32 v71, 0
    v_mov_b32 v72, 0
    v_mov_b32 v73, 0
    v_mov_b32 v74, 0
    v_mov_b32 v75, 0
    v_mov_b32 v76, 0
    v_mov_b32 v77, 0
    v_mov_b32 v78, 0
    v_mov_b32 v79, 0
    v_mov_b32 v80, 0
    v_mov_b32 v81, 0
    v_mov_b32 v82, 0
    v_mov_b32 v83, 0
    v_mov_b32 v84, 0
    v_mov_b32 v85, 0
    v_mov_b32 v86, 0
    v_mov_b32 v87, 0
    v_mov_b32 v88, 0
    v_mov_b32 v89, 0
    v_mov_b32 v90, 0
    v_mov_b32 v91, 0
    v_mov_b32 v92, 0
    v_mov_b32 v93, 0
    v_mov_b32 v94, 0
    v_mov_b32 v95, 0
    v_mov_b32 v96, 0
    v_mov_b32 v97, 0
    v_mov_b32 v98, 0
    v_mov_b32 v99, 0
    v_mov_b32 v100, 0
    v_mov_b32 v101, 0
    v_mov_b32 v102, 0
    v_mov_b32 v103, 0
    v_mov_b32 v104, 0
    v_mov_b32 v105, 0
    v_mov_b32 v106, 0
    v_mov_b32 v107, 0
    v_mov_b32 v108, 0
    v_mov_b32 v109, 0
    v_mov_b32 v110, 0
    v_mov_b32 v111, 0
    v_mov_b32 v112, 0
    v_mov_b32 v113, 0
    v_mov_b32 v114, 0
    v_mov_b32 v115, 0
    v_mov_b32 v116, 0
    v_mov_b32 v117, 0
    v_mov_b32 v118, 0
    v_mov_b32 v119, 0
    v_mov_b32 v120, 0
    v_mov_b32 v121, 0
    v_mov_b32 v122, 0
    v_mov_b32 v123, 0
    v_mov_b32 v124, 0
    v_mov_b32 v125, 0
    v_mov_b32 v126, 0
    v_mov_b32 v127, 0
    s_lshr_b32 s35, s32, 2
    s_lshl_b32 s43, s34, 1
    s_add_u32 s43, s43, s35
    s_lshl_b32 s44, s43, 15
    s_lshl_b32 s43, s43, 5
    s_lshl_b32 s35, s33, 2
    s_add_u32 s43, s43, s35
    s_and_b32 s35, s32, 3
    s_add_u32 s43, s43, s35
    s_lshl_b32 s43, s43, 10
    buffer_load_dwordx4 v[128:131], v4, s[20:23], s43 offen
    s_waitcnt vmcnt(11)
    ds_read_b64_tr_b16 v[48:49], v5
    ds_read_b64_tr_b16 v[50:51], v5 offset:512
    ds_read_b64_tr_b16 v[52:53], v5 offset:1024
    ds_read_b64_tr_b16 v[54:55], v5 offset:1536
    s_waitcnt vmcnt(10) lgkmcnt(2)
    v_mfma_f32_32x32x16_bf16 v[64:79], v[48:51], v[16:19], v[64:79]
    s_waitcnt vmcnt(7)
    ds_read_b64_tr_b16 v[56:57], v5 offset:2048
    s_waitcnt lgkmcnt(1)
    v_mfma_f32_32x32x16_bf16 v[80:95], v[52:55], v[16:19], v[80:95]
    ds_read_b64_tr_b16 v[58:59], v5 offset:2560
    ds_read_b64_tr_b16 v[60:61], v5 offset:3072
    v_mfma_f32_32x32x16_bf16 v[96:111], v[48:51], v[20:23], v[96:111]
    ds_read_b64_tr_b16 v[62:63], v5 offset:3584
    s_add_u32 s46, s45, 3
    s_cmp_ge_u32 s46, 14
    s_cselect_b32 s47, 14, 0
    s_sub_u32 s46, s46, s47
    s_lshl_b32 s47, s46, 10
    s_add_u32 s35, s39, s47
    buffer_load_dwordx4 v[40:43], v4, s[12:15], s35 offen
    s_add_u32 s35, s40, s47
    buffer_load_dwordx4 v[44:47], v4, s[12:15], s35 offen
    v_mfma_f32_32x32x16_bf16 v[112:127], v[52:55], v[20:23], v[112:127]
    s_add_u32 s46, s45, 3
    s_cmp_ge_u32 s46, 14
    s_cselect_b32 s47, 14, 0
    s_sub_u32 s46, s46, s47
    s_lshl_b32 s47, s46, 14
    s_add_u32 s47, s47, s38
    s_add_u32 s36, s37, 6144
    s_mov_b32 m0, s36
    s_add_u32 s35, s47, 0
    buffer_load_dwordx4 v3, s[16:19], s35 offen lds
    s_add_u32 s36, s37, 7168
    s_mov_b32 m0, s36
    s_add_u32 s35, s47, 64
    buffer_load_dwordx4 v3, s[16:19], s35 offen lds
    s_waitcnt vmcnt(10) lgkmcnt(2)
    v_mfma_f32_32x32x16_bf16 v[64:79], v[56:59], v[24:27], v[64:79]
    s_waitcnt vmcnt(7)
    ds_read_b64_tr_b16 v[48:49], v5 offset:4096
    s_waitcnt lgkmcnt(1)
    v_mfma_f32_32x32x16_bf16 v[80:95], v[60:63], v[24:27], v[80:95]
    ds_read_b64_tr_b16 v[50:51], v5 offset:4608
    ds_read_b64_tr_b16 v[52:53], v5 offset:5120
    v_mfma_f32_32x32x16_bf16 v[96:111], v[56:59], v[28:31], v[96:111]
    ds_read_b64_tr_b16 v[54:55], v5 offset:5632
    s_add_u32 s46, s45, 4
    s_cmp_ge_u32 s46, 14
    s_cselect_b32 s47, 14, 0
    s_sub_u32 s46, s46, s47
    s_lshl_b32 s47, s46, 10
    s_add_u32 s35, s39, s47
    buffer_load_dwordx4 v[16:19], v4, s[12:15], s35 offen
    s_add_u32 s35, s40, s47
    buffer_load_dwordx4 v[20:23], v4, s[12:15], s35 offen
    v_mfma_f32_32x32x16_bf16 v[112:127], v[60:63], v[28:31], v[112:127]
    s_add_u32 s46, s45, 4
    s_cmp_ge_u32 s46, 14
    s_cselect_b32 s47, 14, 0
    s_sub_u32 s46, s46, s47
    s_lshl_b32 s47, s46, 14
    s_add_u32 s47, s47, s38
    s_add_u32 s36, s37, 8192
    s_mov_b32 m0, s36
    s_add_u32 s35, s47, 0
    buffer_load_dwordx4 v3, s[16:19], s35 offen lds
    s_add_u32 s36, s37, 9216
    s_mov_b32 m0, s36
    s_add_u32 s35, s47, 64
    buffer_load_dwordx4 v3, s[16:19], s35 offen lds
    s_waitcnt vmcnt(10) lgkmcnt(2)
    v_mfma_f32_32x32x16_bf16 v[64:79], v[48:51], v[32:35], v[64:79]
    s_waitcnt vmcnt(4)
    ds_read_b64_tr_b16 v[56:57], v5 offset:6144
    s_waitcnt lgkmcnt(1)
    v_mfma_f32_32x32x16_bf16 v[80:95], v[52:55], v[32:35], v[80:95]
    ds_read_b64_tr_b16 v[58:59], v5 offset:6656
    ds_read_b64_tr_b16 v[60:61], v5 offset:7168
    v_mfma_f32_32x32x16_bf16 v[96:111], v[48:51], v[36:39], v[96:111]
    ds_read_b64_tr_b16 v[62:63], v5 offset:7680
    s_add_u32 s46, s45, 5
    s_cmp_ge_u32 s46, 14
    s_cselect_b32 s47, 14, 0
    s_sub_u32 s46, s46, s47
    s_lshl_b32 s47, s46, 10
    s_add_u32 s35, s39, s47
    buffer_load_dwordx4 v[24:27], v4, s[12:15], s35 offen
    s_add_u32 s35, s40, s47
    buffer_load_dwordx4 v[28:31], v4, s[12:15], s35 offen
    v_mfma_f32_32x32x16_bf16 v[112:127], v[52:55], v[36:39], v[112:127]
    s_add_u32 s46, s45, 5
    s_cmp_ge_u32 s46, 14
    s_cselect_b32 s47, 14, 0
    s_sub_u32 s46, s46, s47
    s_lshl_b32 s47, s46, 14
    s_add_u32 s47, s47, s38
    s_add_u32 s36, s37, 10240
    s_mov_b32 m0, s36
    s_add_u32 s35, s47, 0
    buffer_load_dwordx4 v3, s[16:19], s35 offen lds
    s_add_u32 s36, s37, 11264
    s_mov_b32 m0, s36
    s_add_u32 s35, s47, 64
    buffer_load_dwordx4 v3, s[16:19], s35 offen lds
    s_waitcnt lgkmcnt(2)
    v_mfma_f32_32x32x16_bf16 v[64:79], v[56:59], v[40:43], v[64:79]
    s_waitcnt vmcnt(4)
    ds_read_b64_tr_b16 v[48:49], v5 offset:8192
    s_waitcnt lgkmcnt(1)
    v_mfma_f32_32x32x16_bf16 v[80:95], v[60:63], v[40:43], v[80:95]
    ds_read_b64_tr_b16 v[50:51], v5 offset:8704
    ds_read_b64_tr_b16 v[52:53], v5 offset:9216
    v_mfma_f32_32x32x16_bf16 v[96:111], v[56:59], v[44:47], v[96:111]
    ds_read_b64_tr_b16 v[54:55], v5 offset:9728
    s_add_u32 s46, s45, 6
    s_cmp_ge_u32 s46, 14
    s_cselect_b32 s47, 14, 0
    s_sub_u32 s46, s46, s47
    s_lshl_b32 s47, s46, 10
    s_add_u32 s35, s39, s47
    buffer_load_dwordx4 v[32:35], v4, s[12:15], s35 offen
    s_add_u32 s35, s40, s47
    buffer_load_dwordx4 v[36:39], v4, s[12:15], s35 offen
    v_mfma_f32_32x32x16_bf16 v[112:127], v[60:63], v[44:47], v[112:127]
    s_add_u32 s46, s45, 6
    s_cmp_ge_u32 s46, 14
    s_cselect_b32 s47, 14, 0
    s_sub_u32 s46, s46, s47
    s_lshl_b32 s47, s46, 14
    s_add_u32 s47, s47, s38
    s_add_u32 s36, s37, 12288
    s_mov_b32 m0, s36
    s_add_u32 s35, s47, 0
    buffer_load_dwordx4 v3, s[16:19], s35 offen lds
    s_add_u32 s36, s37, 13312
    s_mov_b32 m0, s36
    s_add_u32 s35, s47, 64
    buffer_load_dwordx4 v3, s[16:19], s35 offen lds
    s_waitcnt lgkmcnt(2)
    v_mfma_f32_32x32x16_bf16 v[64:79], v[48:51], v[16:19], v[64:79]
    s_waitcnt vmcnt(4)
    ds_read_b64_tr_b16 v[56:57], v5 offset:10240
    s_waitcnt lgkmcnt(1)
    v_mfma_f32_32x32x16_bf16 v[80:95], v[52:55], v[16:19], v[80:95]
    ds_read_b64_tr_b16 v[58:59], v5 offset:10752
    ds_read_b64_tr_b16 v[60:61], v5 offset:11264
    v_mfma_f32_32x32x16_bf16 v[96:111], v[48:51], v[20:23], v[96:111]
    ds_read_b64_tr_b16 v[62:63], v5 offset:11776
    s_add_u32 s46, s45, 7
    s_cmp_ge_u32 s46, 14
    s_cselect_b32 s47, 14, 0
    s_sub_u32 s46, s46, s47
    s_lshl_b32 s47, s46, 10
    s_add_u32 s35, s39, s47
    buffer_load_dwordx4 v[40:43], v4, s[12:15], s35 offen
    s_add_u32 s35, s40, s47
    buffer_load_dwordx4 v[44:47], v4, s[12:15], s35 offen
    v_mfma_f32_32x32x16_bf16 v[112:127], v[52:55], v[20:23], v[112:127]
    s_add_u32 s46, s45, 7
    s_cmp_ge_u32 s46, 14
    s_cselect_b32 s47, 14, 0
    s_sub_u32 s46, s46, s47
    s_lshl_b32 s47, s46, 14
    s_add_u32 s47, s47, s38
    s_add_u32 s36, s37, 14336
    s_mov_b32 m0, s36
    s_add_u32 s35, s47, 0
    buffer_load_dwordx4 v3, s[16:19], s35 offen lds
    s_add_u32 s36, s37, 15360
    s_mov_b32 m0, s36
    s_add_u32 s35, s47, 64
    buffer_load_dwordx4 v3, s[16:19], s35 offen lds
    s_waitcnt lgkmcnt(2)
    v_mfma_f32_32x32x16_bf16 v[64:79], v[56:59], v[24:27], v[64:79]
    s_waitcnt vmcnt(4)
    ds_read_b64_tr_b16 v[48:49], v5 offset:12288
    s_waitcnt lgkmcnt(1)
    v_mfma_f32_32x32x16_bf16 v[80:95], v[60:63], v[24:27], v[80:95]
    ds_read_b64_tr_b16 v[50:51], v5 offset:12800
    ds_read_b64_tr_b16 v[52:53], v5 offset:13312
    v_mfma_f32_32x32x16_bf16 v[96:111], v[56:59], v[28:31], v[96:111]
    ds_read_b64_tr_b16 v[54:55], v5 offset:13824
    s_add_u32 s46, s45, 8
    s_cmp_ge_u32 s46, 14
    s_cselect_b32 s47, 14, 0
    s_sub_u32 s46, s46, s47
    s_lshl_b32 s47, s46, 10
    s_add_u32 s35, s39, s47
    buffer_load_dwordx4 v[16:19], v4, s[12:15], s35 offen
    s_add_u32 s35, s40, s47
    buffer_load_dwordx4 v[20:23], v4, s[12:15], s35 offen
    v_mfma_f32_32x32x16_bf16 v[112:127], v[60:63], v[28:31], v[112:127]
    s_add_u32 s46, s45, 8
    s_cmp_ge_u32 s46, 14
    s_cselect_b32 s47, 14, 0
    s_sub_u32 s46, s46, s47
    s_lshl_b32 s47, s46, 14
    s_add_u32 s47, s47, s38
    s_add_u32 s36, s37, 0
    s_mov_b32 m0, s36
    s_add_u32 s35, s47, 0
    buffer_load_dwordx4 v3, s[16:19], s35 offen lds
    s_add_u32 s36, s37, 1024
    s_mov_b32 m0, s36
    s_add_u32 s35, s47, 64
    buffer_load_dwordx4 v3, s[16:19], s35 offen lds
    s_waitcnt lgkmcnt(2)
    v_mfma_f32_32x32x16_bf16 v[64:79], v[48:51], v[32:35], v[64:79]
    s_waitcnt vmcnt(4)
    ds_read_b64_tr_b16 v[56:57], v5 offset:14336
    s_waitcnt lgkmcnt(1)
    v_mfma_f32_32x32x16_bf16 v[80:95], v[52:55], v[32:35], v[80:95]
    ds_read_b64_tr_b16 v[58:59], v5 offset:14848
    ds_read_b64_tr_b16 v[60:61], v5 offset:15360
    v_mfma_f32_32x32x16_bf16 v[96:111], v[48:51], v[36:39], v[96:111]
    ds_read_b64_tr_b16 v[62:63], v5 offset:15872
    s_add_u32 s46, s45, 9
    s_cmp_ge_u32 s46, 14
    s_cselect_b32 s47, 14, 0
    s_sub_u32 s46, s46, s47
    s_lshl_b32 s47, s46, 10
    s_add_u32 s35, s39, s47
    buffer_load_dwordx4 v[24:27], v4, s[12:15], s35 offen
    s_add_u32 s35, s40, s47
    buffer_load_dwordx4 v[28:31], v4, s[12:15], s35 offen
    v_mfma_f32_32x32x16_bf16 v[112:127], v[52:55], v[36:39], v[112:127]
    s_add_u32 s46, s45, 9
    s_cmp_ge_u32 s46, 14
    s_cselect_b32 s47, 14, 0
    s_sub_u32 s46, s46, s47
    s_lshl_b32 s47, s46, 14
    s_add_u32 s47, s47, s38
    s_add_u32 s36, s37, 2048
    s_mov_b32 m0, s36
    s_add_u32 s35, s47, 0
    buffer_load_dwordx4 v3, s[16:19], s35 offen lds
    s_add_u32 s36, s37, 3072
    s_mov_b32 m0, s36
    s_add_u32 s35, s47, 64
    buffer_load_dwordx4 v3, s[16:19], s35 offen lds
    s_waitcnt lgkmcnt(2)
    v_mfma_f32_32x32x16_bf16 v[64:79], v[56:59], v[40:43], v[64:79]
    s_waitcnt vmcnt(4)
    ds_read_b64_tr_b16 v[48:49], v5
    s_waitcnt lgkmcnt(1)
    v_mfma_f32_32x32x16_bf16 v[80:95], v[60:63], v[40:43], v[80:95]
    ds_read_b64_tr_b16 v[50:51], v5 offset:512
    ds_read_b64_tr_b16 v[52:53], v5 offset:1024
    v_mfma_f32_32x32x16_bf16 v[96:111], v[56:59], v[44:47], v[96:111]
    ds_read_b64_tr_b16 v[54:55], v5 offset:1536
    s_add_u32 s46, s45, 10
    s_cmp_ge_u32 s46, 14
    s_cselect_b32 s47, 14, 0
    s_sub_u32 s46, s46, s47
    s_lshl_b32 s47, s46, 10
    s_add_u32 s35, s39, s47
    buffer_load_dwordx4 v[32:35], v4, s[12:15], s35 offen
    s_add_u32 s35, s40, s47
    buffer_load_dwordx4 v[36:39], v4, s[12:15], s35 offen
    v_mfma_f32_32x32x16_bf16 v[112:127], v[60:63], v[44:47], v[112:127]
    s_add_u32 s46, s45, 10
    s_cmp_ge_u32 s46, 14
    s_cselect_b32 s47, 14, 0
    s_sub_u32 s46, s46, s47
    s_lshl_b32 s47, s46, 14
    s_add_u32 s47, s47, s38
    s_add_u32 s36, s37, 4096
    s_mov_b32 m0, s36
    s_add_u32 s35, s47, 0
    buffer_load_dwordx4 v3, s[16:19], s35 offen lds
    s_add_u32 s36, s37, 5120
    s_mov_b32 m0, s36
    s_add_u32 s35, s47, 64
    buffer_load_dwordx4 v3, s[16:19], s35 offen lds
    s_waitcnt lgkmcnt(2)
    v_mfma_f32_32x32x16_bf16 v[64:79], v[48:51], v[16:19], v[64:79]
    s_waitcnt vmcnt(4)
    ds_read_b64_tr_b16 v[56:57], v5 offset:2048
    s_waitcnt lgkmcnt(1)
    v_mfma_f32_32x32x16_bf16 v[80:95], v[52:55], v[16:19], v[80:95]
    ds_read_b64_tr_b16 v[58:59], v5 offset:2560
    ds_read_b64_tr_b16 v[60:61], v5 offset:3072
    v_mfma_f32_32x32x16_bf16 v[96:111], v[48:51], v[20:23], v[96:111]
    ds_read_b64_tr_b16 v[62:63], v5 offset:3584
    s_add_u32 s46, s45, 11
    s_cmp_ge_u32 s46, 14
    s_cselect_b32 s47, 14, 0
    s_sub_u32 s46, s46, s47
    s_lshl_b32 s47, s46, 10
    s_add_u32 s35, s39, s47
    buffer_load_dwordx4 v[40:43], v4, s[12:15], s35 offen
    s_add_u32 s35, s40, s47
    buffer_load_dwordx4 v[44:47], v4, s[12:15], s35 offen
    v_mfma_f32_32x32x16_bf16 v[112:127], v[52:55], v[20:23], v[112:127]
    s_add_u32 s46, s45, 11
    s_cmp_ge_u32 s46, 14
    s_cselect_b32 s47, 14, 0
    s_sub_u32 s46, s46, s47
    s_lshl_b32 s47, s46, 14
    s_add_u32 s47, s47, s38
    s_add_u32 s36, s37, 6144
    s_mov_b32 m0, s36
    s_add_u32 s35, s47, 0
    buffer_load_dwordx4 v3, s[16:19], s35 offen lds
    s_add_u32 s36, s37, 7168
    s_mov_b32 m0, s36
    s_add_u32 s35, s47, 64
    buffer_load_dwordx4 v3, s[16:19], s35 offen lds
    s_waitcnt lgkmcnt(2)
    v_mfma_f32_32x32x16_bf16 v[64:79], v[56:59], v[24:27], v[64:79]
    s_waitcnt vmcnt(4)
    ds_read_b64_tr_b16 v[48:49], v5 offset:4096
    s_waitcnt lgkmcnt(1)
    v_mfma_f32_32x32x16_bf16 v[80:95], v[60:63], v[24:27], v[80:95]
    ds_read_b64_tr_b16 v[50:51], v5 offset:4608
    ds_read_b64_tr_b16 v[52:53], v5 offset:5120
    v_mfma_f32_32x32x16_bf16 v[96:111], v[56:59], v[28:31], v[96:111]
    ds_read_b64_tr_b16 v[54:55], v5 offset:5632
    s_add_u32 s46, s45, 12
    s_cmp_ge_u32 s46, 14
    s_cselect_b32 s47, 14, 0
    s_sub_u32 s46, s46, s47
    s_lshl_b32 s47, s46, 10
    s_add_u32 s35, s39, s47
    buffer_load_dwordx4 v[16:19], v4, s[12:15], s35 offen
    s_add_u32 s35, s40, s47
    buffer_load_dwordx4 v[20:23], v4, s[12:15], s35 offen
    v_mfma_f32_32x32x16_bf16 v[112:127], v[60:63], v[28:31], v[112:127]
    s_add_u32 s46, s45, 12
    s_cmp_ge_u32 s46, 14
    s_cselect_b32 s47, 14, 0
    s_sub_u32 s46, s46, s47
    s_lshl_b32 s47, s46, 14
    s_add_u32 s47, s47, s38
    s_add_u32 s36, s37, 8192
    s_mov_b32 m0, s36
    s_add_u32 s35, s47, 0
    buffer_load_dwordx4 v3, s[16:19], s35 offen lds
    s_add_u32 s36, s37, 9216
    s_mov_b32 m0, s36
    s_add_u32 s35, s47, 64
    buffer_load_dwordx4 v3, s[16:19], s35 offen lds
    s_waitcnt lgkmcnt(2)
    v_mfma_f32_32x32x16_bf16 v[64:79], v[48:51], v[32:35], v[64:79]
    s_waitcnt vmcnt(4)
    ds_read_b64_tr_b16 v[56:57], v5 offset:6144
    s_waitcnt lgkmcnt(1)
    v_mfma_f32_32x32x16_bf16 v[80:95], v[52:55], v[32:35], v[80:95]
    ds_read_b64_tr_b16 v[58:59], v5 offset:6656
    ds_read_b64_tr_b16 v[60:61], v5 offset:7168
    v_mfma_f32_32x32x16_bf16 v[96:111], v[48:51], v[36:39], v[96:111]
    ds_read_b64_tr_b16 v[62:63], v5 offset:7680
    s_add_u32 s46, s45, 13
    s_cmp_ge_u32 s46, 14
    s_cselect_b32 s47, 14, 0
    s_sub_u32 s46, s46, s47
    s_lshl_b32 s47, s46, 10
    s_add_u32 s35, s39, s47
    buffer_load_dwordx4 v[24:27], v4, s[12:15], s35 offen
    s_add_u32 s35, s40, s47
    buffer_load_dwordx4 v[28:31], v4, s[12:15], s35 offen
    v_mfma_f32_32x32x16_bf16 v[112:127], v[52:55], v[36:39], v[112:127]
    s_add_u32 s46, s45, 13
    s_cmp_ge_u32 s46, 14
    s_cselect_b32 s47, 14, 0
    s_sub_u32 s46, s46, s47
    s_lshl_b32 s47, s46, 14
    s_add_u32 s47, s47, s38
    s_add_u32 s36, s37, 10240
    s_mov_b32 m0, s36
    s_add_u32 s35, s47, 0
    buffer_load_dwordx4 v3, s[16:19], s35 offen lds
    s_add_u32 s36, s37, 11264
    s_mov_b32 m0, s36
    s_add_u32 s35, s47, 64
    buffer_load_dwordx4 v3, s[16:19], s35 offen lds
    s_waitcnt lgkmcnt(2)
    v_mfma_f32_32x32x16_bf16 v[64:79], v[56:59], v[40:43], v[64:79]
    s_waitcnt vmcnt(4)
    ds_read_b64_tr_b16 v[48:49], v5 offset:8192
    s_waitcnt lgkmcnt(1)
    v_mfma_f32_32x32x16_bf16 v[80:95], v[60:63], v[40:43], v[80:95]
    ds_read_b64_tr_b16 v[50:51], v5 offset:8704
    v_mfma_f32_32x32x16_bf16 v[96:111], v[56:59], v[44:47], v[96:111]
    ds_read_b64_tr_b16 v[52:53], v5 offset:9216
    v_mfma_f32_32x32x16_bf16 v[112:127], v[60:63], v[44:47], v[112:127]
    ds_read_b64_tr_b16 v[54:55], v5 offset:9728
    s_waitcnt lgkmcnt(2)
    v_mfma_f32_32x32x16_bf16 v[64:79], v[48:51], v[16:19], v[64:79]
    s_waitcnt vmcnt(0)
    ds_read_b64_tr_b16 v[56:57], v5 offset:10240
    s_waitcnt lgkmcnt(1)
    v_mfma_f32_32x32x16_bf16 v[80:95], v[52:55], v[16:19], v[80:95]
    ds_read_b64_tr_b16 v[58:59], v5 offset:10752
    v_mfma_f32_32x32x16_bf16 v[96:111], v[48:51], v[20:23], v[96:111]
    ds_read_b64_tr_b16 v[60:61], v5 offset:11264
    v_mfma_f32_32x32x16_bf16 v[112:127], v[52:55], v[20:23], v[112:127]
    ds_read_b64_tr_b16 v[62:63], v5 offset:11776
    s_waitcnt lgkmcnt(2)
    v_mfma_f32_32x32x16_bf16 v[64:79], v[56:59], v[24:27], v[64:79]
    s_waitcnt lgkmcnt(0)
    v_mfma_f32_32x32x16_bf16 v[80:95], v[60:63], v[24:27], v[80:95]
    v_mfma_f32_32x32x16_bf16 v[96:111], v[56:59], v[28:31], v[96:111]
    v_mfma_f32_32x32x16_bf16 v[112:127], v[60:63], v[28:31], v[112:127]
    s_barrier
    v_add_u32 v6, s37, v4
    s_nop 5
    ds_write_b128 v6, v[64:67]
    ds_write_b128 v6, v[68:71] offset:1024
    ds_write_b128 v6, v[72:75] offset:2048
    ds_write_b128 v6, v[76:79] offset:3072
    ds_write_b128 v6, v[80:83] offset:4096
    ds_write_b128 v6, v[84:87] offset:5120
    ds_write_b128 v6, v[88:91] offset:6144
    ds_write_b128 v6, v[92:95] offset:7168
    ds_write_b128 v6, v[96:99] offset:8192
    ds_write_b128 v6, v[100:103] offset:9216
    ds_write_b128 v6, v[104:107] offset:10240
    ds_write_b128 v6, v[108:111] offset:11264
    ds_write_b128 v6, v[112:115] offset:12288
    ds_write_b128 v6, v[116:119] offset:13312
    ds_write_b128 v6, v[120:123] offset:14336
    ds_write_b128 v6, v[124:127] offset:15360
    s_waitcnt lgkmcnt(0)
    s_barrier
    v_lshl_add_u32 v7, v2, 11, v4
    v_add_u32 v11, 65536, v7
    ds_read_b128 v[136:139], v7
    ds_read_b128 v[140:143], v7 offset:1024
    ds_read_b128 v[144:147], v7 offset:16384
    ds_read_b128 v[148:151], v7 offset:17408
    ds_read_b128 v[152:155], v7 offset:32768
    ds_read_b128 v[156:159], v7 offset:33792
    ds_read_b128 v[160:163], v7 offset:49152
    ds_read_b128 v[164:167], v7 offset:50176
    ds_read_b128 v[168:171], v11
    ds_read_b128 v[172:175], v11 offset:1024
    ds_read_b128 v[176:179], v11 offset:16384
    ds_read_b128 v[180:183], v11 offset:17408
    ds_read_b128 v[184:187], v11 offset:32768
    ds_read_b128 v[188:191], v11 offset:33792
    ds_read_b128 v[192:195], v11 offset:49152
    ds_read_b128 v[196:199], v11 offset:50176
    s_waitcnt lgkmcnt(13)
    v_add_f32 v200, v136, v144
    v_add_f32 v201, v137, v145
    v_add_f32 v202, v138, v146
    v_add_f32 v203, v139, v147
    s_waitcnt lgkmcnt(12)
    v_add_f32 v204, v140, v148
    v_add_f32 v205, v141, v149
    v_add_f32 v206, v142, v150
    v_add_f32 v207, v143, v151
    s_waitcnt lgkmcnt(11)
    v_add_f32 v200, v200, v152
    v_add_f32 v201, v201, v153
    v_add_f32 v202, v202, v154
    v_add_f32 v203, v203, v155
    s_waitcnt lgkmcnt(10)
    v_add_f32 v204, v204, v156
    v_add_f32 v205, v205, v157
    v_add_f32 v206, v206, v158
    v_add_f32 v207, v207, v159
    s_waitcnt lgkmcnt(9)
    v_add_f32 v200, v200, v160
    v_add_f32 v201, v201, v161
    v_add_f32 v202, v202, v162
    v_add_f32 v203, v203, v163
    s_waitcnt lgkmcnt(8)
    v_add_f32 v204, v204, v164
    v_add_f32 v205, v205, v165
    v_add_f32 v206, v206, v166
    v_add_f32 v207, v207, v167
    s_waitcnt lgkmcnt(7)
    v_add_f32 v200, v200, v168
    v_add_f32 v201, v201, v169
    v_add_f32 v202, v202, v170
    v_add_f32 v203, v203, v171
    s_waitcnt lgkmcnt(6)
    v_add_f32 v204, v204, v172
    v_add_f32 v205, v205, v173
    v_add_f32 v206, v206, v174
    v_add_f32 v207, v207, v175
    s_waitcnt lgkmcnt(5)
    v_add_f32 v200, v200, v176
    v_add_f32 v201, v201, v177
    v_add_f32 v202, v202, v178
    v_add_f32 v203, v203, v179
    s_waitcnt lgkmcnt(4)
    v_add_f32 v204, v204, v180
    v_add_f32 v205, v205, v181
    v_add_f32 v206, v206, v182
    v_add_f32 v207, v207, v183
    s_waitcnt lgkmcnt(3)
    v_add_f32 v200, v200, v184
    v_add_f32 v201, v201, v185
    v_add_f32 v202, v202, v186
    v_add_f32 v203, v203, v187
    s_waitcnt lgkmcnt(2)
    v_add_f32 v204, v204, v188
    v_add_f32 v205, v205, v189
    v_add_f32 v206, v206, v190
    v_add_f32 v207, v207, v191
    s_waitcnt lgkmcnt(1)
    v_add_f32 v200, v200, v192
    v_add_f32 v201, v201, v193
    v_add_f32 v202, v202, v194
    v_add_f32 v203, v203, v195
    s_waitcnt lgkmcnt(0)
    v_add_f32 v204, v204, v196
    v_add_f32 v205, v205, v197
    v_add_f32 v206, v206, v198
    v_add_f32 v207, v207, v199
    v_cvt_pk_bf16_f32 v208, v200, v201
    v_cvt_pk_bf16_f32 v209, v202, v203
    v_cvt_pk_bf16_f32 v210, v204, v205
    v_cvt_pk_bf16_f32 v211, v206, v207
    v_lshlrev_b32 v136, 16, v208
    v_and_b32 v137, 4294901760, v208
    v_lshlrev_b32 v144, 16, v128
    v_and_b32 v145, 4294901760, v128
    v_lshlrev_b32 v138, 16, v209
    v_and_b32 v139, 4294901760, v209
    v_lshlrev_b32 v146, 16, v129
    v_and_b32 v147, 4294901760, v129
    v_lshlrev_b32 v140, 16, v210
    v_and_b32 v141, 4294901760, v210
    v_lshlrev_b32 v148, 16, v130
    v_and_b32 v149, 4294901760, v130
    v_lshlrev_b32 v142, 16, v211
    v_and_b32 v143, 4294901760, v211
    v_lshlrev_b32 v150, 16, v131
    v_and_b32 v151, 4294901760, v131
    v_add_f32 v136, v136, v144
    v_add_f32 v137, v137, v145
    v_add_f32 v138, v138, v146
    v_add_f32 v139, v139, v147
    v_add_f32 v140, v140, v148
    v_add_f32 v141, v141, v149
    v_add_f32 v142, v142, v150
    v_add_f32 v143, v143, v151
    v_cvt_pk_bf16_f32 v152, v136, v137
    v_cvt_pk_bf16_f32 v153, v138, v139
    v_cvt_pk_bf16_f32 v154, v140, v141
    v_cvt_pk_bf16_f32 v155, v142, v143
    v_and_b32 v8, 31, v1
    v_lshlrev_b32 v10, 10, v8
    v_lshrrev_b32 v9, 5, v1
    v_lshl_add_u32 v10, v9, 3, v10
    s_lshl_b32 s35, s33, 7
    s_add_u32 s44, s44, s35
    s_and_b32 s35, s32, 3
    s_lshl_b32 s35, s35, 5
    s_add_u32 s44, s44, s35
    buffer_store_dwordx2 v[152:153], v10, s[24:27], s44 offen
    buffer_store_dwordx2 v[154:155], v10, s[24:27], s44 offen offset:16
k4_ffn2_kernel_end:
    s_endpgm
.section .rodata,"a"
.p2align 6
.amdhsa_kernel k0_ln1_kernel
  .amdhsa_next_free_vgpr 108
  .amdhsa_next_free_sgpr 43
  .amdhsa_accum_offset 108
  .amdhsa_group_segment_fixed_size 0
  .amdhsa_kernarg_size 88
  .amdhsa_user_sgpr_count 2
  .amdhsa_user_sgpr_kernarg_segment_ptr 1
  .amdhsa_system_sgpr_workgroup_id_x 1
.end_amdhsa_kernel
.amdhsa_kernel k1_qkv_kernel
  .amdhsa_next_free_vgpr 214
  .amdhsa_next_free_sgpr 60
  .amdhsa_accum_offset 216
  .amdhsa_group_segment_fixed_size 0
  .amdhsa_kernarg_size 88
  .amdhsa_user_sgpr_count 2
  .amdhsa_user_sgpr_kernarg_segment_ptr 1
  .amdhsa_system_sgpr_workgroup_id_x 1
.end_amdhsa_kernel
.amdhsa_kernel k2_attn_kernel
  .amdhsa_next_free_vgpr 256
  .amdhsa_next_free_sgpr 56
  .amdhsa_accum_offset 256
  .amdhsa_group_segment_fixed_size 0
  .amdhsa_kernarg_size 88
  .amdhsa_user_sgpr_count 2
  .amdhsa_user_sgpr_kernarg_segment_ptr 1
  .amdhsa_system_sgpr_workgroup_id_x 1
.end_amdhsa_kernel
.amdhsa_kernel k3_ffn1_kernel
  .amdhsa_next_free_vgpr 236
  .amdhsa_next_free_sgpr 72
  .amdhsa_accum_offset 180
  .amdhsa_group_segment_fixed_size 0
  .amdhsa_kernarg_size 88
  .amdhsa_user_sgpr_count 2
  .amdhsa_user_sgpr_kernarg_segment_ptr 1
  .amdhsa_system_sgpr_workgroup_id_x 1
.end_amdhsa_kernel
.amdhsa_kernel k4_ffn2_kernel
  .amdhsa_next_free_vgpr 212
  .amdhsa_next_free_sgpr 48
  .amdhsa_accum_offset 212
  .amdhsa_group_segment_fixed_size 0
  .amdhsa_kernarg_size 88
  .amdhsa_user_sgpr_count 2
  .amdhsa_user_sgpr_kernarg_segment_ptr 1
  .amdhsa_system_sgpr_workgroup_id_x 1
.end_amdhsa_kernel
```
